```python
import torch

def _softmax(x, axis=-1):
    return torch.softmax(x, dim=axis)
def _gelu(x):
    return torch.nn.functional.gelu(x, approximate="tanh")
def _silu(x):
    return torch.nn.functional.silu(x)
def _sigmoid(x):
    return torch.sigmoid(x)
def _layernorm(x, axis=-1, eps=1e-5):
    m = x.mean(dim=axis, keepdim=True)
    v = x.var(dim=axis, keepdim=True, unbiased=False)
    return (x - m) / torch.sqrt(v + eps)
def _scatter_add(tgt, idx, src, axis=0):
    return tgt.clone().index_add_(axis, idx, src)
def _segment_sum(src, seg, n):
    out = torch.zeros((n,) + src.shape[1:], dtype=src.dtype)
    return out.index_add_(0, seg, src)
def _pad(x, pw):
    flat = tuple(v for pair in reversed(pw) for v in pair)
    return torch.nn.functional.pad(x, flat)

kernel_name = 'recurrent_scan__gqa_block_cached__swiglu_ffn__decode'

def setup_inputs():

    _w = (lambda a: (lambda t: t.to(torch.bfloat16) if t.is_floating_point() else t)(torch.as_tensor(a)))
    def _A_setup():
        B, Sq, D = 2, 1, 1024
        Hq, Hkv, Sk, Dh = 32, 4, 32768, 128
        assert Hq % Hkv == 0, (Hq, Hkv)
        return {
            "x": _w((lambda *s: torch.randn(*s, dtype=torch.bfloat16) * 0.05)(B, Sq, D)),
            "k_cache": _w((lambda *s: torch.randn(*s, dtype=torch.bfloat16) * 1.6)(B, Hkv, Sk, Dh)),
            "v_cache": _w((lambda *s: torch.randn(*s, dtype=torch.bfloat16) * 0.2)(B, Hkv, Sk, Dh)),
            "wq": _w((lambda *s: torch.randn(*s, dtype=torch.bfloat16) * 1.6)(D, Hq * Dh) * (D ** -0.5)),
            "wo": _w((lambda *s: torch.randn(*s, dtype=torch.bfloat16) * 0.2)(Hq * Dh, D) * ((Hq * Dh) ** -0.5)),
        }
    _A_in = _A_setup()

    def _B_setup():
        B, S, D, F = 2, 1, 1024, 3584
        return {
            "x": _w((lambda *s: torch.randn(*s, dtype=torch.bfloat16) * 0.05)(B, S, D)),
            "w_gate": _w((lambda *s: torch.randn(*s, dtype=torch.bfloat16) * 0.1)(D, F)),
            "w_up": _w((lambda *s: torch.randn(*s, dtype=torch.bfloat16) * 0.1)(D, F)),
            "w_down": _w((lambda *s: torch.randn(*s, dtype=torch.bfloat16) * 0.1)(F, D)),
        }
    _B_in = _B_setup()

    return {
        "A_x": _A_in["x"],
        "A_k_cache": _A_in["k_cache"],
        "A_v_cache": _A_in["v_cache"],
        "A_wq": _A_in["wq"],
        "A_wo": _A_in["wo"],
        "B_x": _B_in["x"],
        "B_w_gate": _B_in["w_gate"],
        "B_w_up": _B_in["w_up"],
        "B_w_down": _B_in["w_down"],
    }

def reference(A_x, A_k_cache, A_v_cache, A_wq, A_wo, B_x, B_w_gate, B_w_up, B_w_down):
    def _A_ref(x, k_cache, v_cache, wq, wo):
        B, Sq, D = x.shape
        Hq, Dh = 32, 128
        Hkv = k_cache.shape[1]
        rep = Hq // Hkv
        q = (lambda x, *d: x.permute(*d))((x @ wq).reshape(B, Sq, Hq, Dh), 0, 2, 1, 3)
        k = (lambda x, n, axis: torch.repeat_interleave(x, n, dim=axis))(k_cache, rep, axis=1)
        v = (lambda x, n, axis: torch.repeat_interleave(x, n, dim=axis))(v_cache, rep, axis=1)
        scores = torch.einsum("bhqd,bhkd->bhqk", q, k) * (Dh ** -0.5)
        p = _softmax(scores, axis=-1)
        o = torch.einsum("bhqk,bhkd->bhqd", p, v)
        return (lambda x, *d: x.permute(*d))(o, 0, 2, 1, 3).reshape(B, Sq, Hq * Dh) @ wo

    def _B_ref(x, w_gate, w_up, w_down):
        g = _silu(x @ w_gate)
        u = x @ w_up
        return (g * u) @ w_down

    x = A_x
    xn = _layernorm(x, axis=-1)
    s = _A_ref(xn, A_k_cache, A_v_cache, A_wq, A_wo)
    g = _silu(_B_ref(xn, B_w_gate, B_w_up, B_w_down))
    return x + s * g
```

```asm
; @launch grid=(256,1,1) block=(512,1,1) lds=155648
.amdgcn_target "amdgcn-amd-amdhsa--gfx950"
.text
.globl recurrent_scan__gqa_block_cached__swiglu_ffn__decode_kernel
.p2align 8
.type recurrent_scan__gqa_block_cached__swiglu_ffn__decode_kernel,@function
recurrent_scan__gqa_block_cached__swiglu_ffn__decode_kernel:
    s_cmp_ge_u32 s2, 256
    s_cbranch_scc1 L_END
    s_load_dwordx16 s[4:19], s[0:1], 0
    s_load_dwordx8 s[20:27], s[0:1], 64
    v_lshrrev_b32 v1, 6, v0
    v_and_b32 v0, 63, v0
    s_mov_b32 s58, 0x05040100
    s_mov_b32 s59, 0x07060302
    v_readfirstlane_b32 s3, v1
    s_mov_b32 s60, 0x3fb8aa3b
    s_mov_b32 s61, 0x3db504f3
    s_waitcnt lgkmcnt(0)
    s_mov_b32 s36, s26
    s_mov_b32 s37, s27
    s_mov_b32 s38, 268435456
    s_mov_b32 s39, 0x20000
    s_mov_b32 s80, 0xcccccccc
    s_mov_b32 s81, 0xcccccccc
    s_mov_b32 s82, 0xf0f0f0f0
    s_mov_b32 s83, 0xf0f0f0f0
    s_mov_b32 s84, 0xff00ff00
    s_mov_b32 s85, 0xff00ff00
    s_mov_b32 s40, s24
    s_mov_b32 s41, s25
    s_mov_b32 s42, 256
    s_mov_b32 s43, 0x20000
    s_and_b32 s90, s2, 7
    s_lshr_b32 s91, s2, 3
    s_lshl_b32 s86, s90, 5
    s_add_u32 s86, s86, s91
    s_lshr_b32 s92, s90, 1
    s_lshl_b32 s92, s92, 6
    s_and_b32 s93, s90, 1
    s_lshl_b32 s87, s91, 1
    s_add_u32 s87, s87, s93
    s_add_u32 s87, s87, s92
    s_lshl_b32 s88, s93, 2
    s_and_b32 s94, s91, 3
    s_add_u32 s88, s88, s94
    s_lshl_b32 s88, s88, 3
    s_lshr_b32 s94, s91, 2
    s_add_u32 s88, s88, s94
    s_add_u32 s88, s88, s92
    s_lshr_b32 s89, s91, 3
    s_lshl_b32 s89, s89, 3
    s_add_u32 s89, s89, s90
    s_cmp_lt_u32 s89, 28
    s_cselect_b32 s95, 1, 0
    s_lshl_b32 s89, s89, 3
    s_and_b32 s94, s91, 7
    s_add_u32 s89, s89, s94
    s_add_u32 s89, s89, 32
    s_mul_i32 s89, s89, s95
    s_mov_b32 s86, s2
    s_mov_b32 s87, s2
    s_mov_b32 s88, s2
    s_mov_b32 s90, 0x07060503
    s_mov_b32 s91, 0x07060502
    s_mov_b32 s92, 0x07060501
    s_mov_b32 s93, 0x04000c0c
    s_mov_b32 s94, 0x0706000c
    s_cmp_ge_u32 s3, 4
    s_cbranch_scc1 L_BULK
    s_cmp_eq_u32 s3, 0
    s_cbranch_scc1 L_A0
    s_cmp_eq_u32 s3, 3
    s_cbranch_scc1 L_A3
    s_branch L_A12
L_A3:
    s_mov_b32 s28, s4
    s_mov_b32 s29, s5
    s_mov_b32 s30, 4096
    s_mov_b32 s31, 0x20000
    v_lshlrev_b32 v1, 6, v0
    buffer_load_dwordx4 v[8:11], v1, s[28:31], 0 offen
    buffer_load_dwordx4 v[12:15], v1, s[28:31], 0 offen offset:16
    buffer_load_dwordx4 v[16:19], v1, s[28:31], 0 offen offset:32
    buffer_load_dwordx4 v[20:23], v1, s[28:31], 0 offen offset:48
    v_mov_b32 v2, 0
    v_lshlrev_b32 v3, 2, v0
    v_add_u32 v3, 6720, v3
    s_mov_b64 exec, 0xffff
    ds_write_b32 v3, v2
    s_mov_b64 exec, -1
    s_waitcnt lgkmcnt(0)
    s_barrier
    s_waitcnt vmcnt(0)
    v_lshlrev_b32 v24, 16, v8
    v_and_b32 v25, 0xffff0000, v8
    v_lshlrev_b32 v26, 16, v9
    v_and_b32 v27, 0xffff0000, v9
    v_lshlrev_b32 v28, 16, v10
    v_and_b32 v29, 0xffff0000, v10
    v_lshlrev_b32 v30, 16, v11
    v_and_b32 v31, 0xffff0000, v11
    v_lshlrev_b32 v32, 16, v12
    v_and_b32 v33, 0xffff0000, v12
    v_lshlrev_b32 v34, 16, v13
    v_and_b32 v35, 0xffff0000, v13
    v_lshlrev_b32 v36, 16, v14
    v_and_b32 v37, 0xffff0000, v14
    v_lshlrev_b32 v38, 16, v15
    v_and_b32 v39, 0xffff0000, v15
    v_lshlrev_b32 v40, 16, v16
    v_and_b32 v41, 0xffff0000, v16
    v_lshlrev_b32 v42, 16, v17
    v_and_b32 v43, 0xffff0000, v17
    v_lshlrev_b32 v44, 16, v18
    v_and_b32 v45, 0xffff0000, v18
    v_lshlrev_b32 v46, 16, v19
    v_and_b32 v47, 0xffff0000, v19
    v_lshlrev_b32 v48, 16, v20
    v_and_b32 v49, 0xffff0000, v20
    v_lshlrev_b32 v50, 16, v21
    v_and_b32 v51, 0xffff0000, v21
    v_lshlrev_b32 v52, 16, v22
    v_and_b32 v53, 0xffff0000, v22
    v_lshlrev_b32 v54, 16, v23
    v_and_b32 v55, 0xffff0000, v23
    v_add_f32 v56, v24, v25
    v_add_f32 v56, v56, v26
    v_add_f32 v56, v56, v27
    v_add_f32 v56, v56, v28
    v_add_f32 v56, v56, v29
    v_add_f32 v56, v56, v30
    v_add_f32 v56, v56, v31
    v_add_f32 v56, v56, v32
    v_add_f32 v56, v56, v33
    v_add_f32 v56, v56, v34
    v_add_f32 v56, v56, v35
    v_add_f32 v56, v56, v36
    v_add_f32 v56, v56, v37
    v_add_f32 v56, v56, v38
    v_add_f32 v56, v56, v39
    v_add_f32 v56, v56, v40
    v_add_f32 v56, v56, v41
    v_add_f32 v56, v56, v42
    v_add_f32 v56, v56, v43
    v_add_f32 v56, v56, v44
    v_add_f32 v56, v56, v45
    v_add_f32 v56, v56, v46
    v_add_f32 v56, v56, v47
    v_add_f32 v56, v56, v48
    v_add_f32 v56, v56, v49
    v_add_f32 v56, v56, v50
    v_add_f32 v56, v56, v51
    v_add_f32 v56, v56, v52
    v_add_f32 v56, v56, v53
    v_add_f32 v56, v56, v54
    v_add_f32 v56, v56, v55
    s_nop 1
    v_add_f32_dpp v57, v56, v56 row_ror:1 row_mask:0xf bank_mask:0xf
    v_mov_b32 v56, v57
    s_nop 1
    v_add_f32_dpp v57, v56, v56 row_ror:2 row_mask:0xf bank_mask:0xf
    v_mov_b32 v56, v57
    s_nop 1
    v_add_f32_dpp v57, v56, v56 row_ror:4 row_mask:0xf bank_mask:0xf
    v_mov_b32 v56, v57
    s_nop 1
    v_add_f32_dpp v57, v56, v56 row_ror:8 row_mask:0xf bank_mask:0xf
    v_mov_b32 v56, v57
    v_mov_b32 v57, v56
    s_nop 1
    v_permlane16_swap_b32 v56, v57
    s_nop 1
    v_add_f32 v56, v56, v57
    v_mul_f32 v56, 0x3a800000, v56
    v_sub_f32 v58, v24, v56
    v_mul_f32 v59, v58, v58
    v_sub_f32 v58, v25, v56
    v_fma_f32 v59, v58, v58, v59
    v_sub_f32 v58, v26, v56
    v_fma_f32 v59, v58, v58, v59
    v_sub_f32 v58, v27, v56
    v_fma_f32 v59, v58, v58, v59
    v_sub_f32 v58, v28, v56
    v_fma_f32 v59, v58, v58, v59
    v_sub_f32 v58, v29, v56
    v_fma_f32 v59, v58, v58, v59
    v_sub_f32 v58, v30, v56
    v_fma_f32 v59, v58, v58, v59
    v_sub_f32 v58, v31, v56
    v_fma_f32 v59, v58, v58, v59
    v_sub_f32 v58, v32, v56
    v_fma_f32 v59, v58, v58, v59
    v_sub_f32 v58, v33, v56
    v_fma_f32 v59, v58, v58, v59
    v_sub_f32 v58, v34, v56
    v_fma_f32 v59, v58, v58, v59
    v_sub_f32 v58, v35, v56
    v_fma_f32 v59, v58, v58, v59
    v_sub_f32 v58, v36, v56
    v_fma_f32 v59, v58, v58, v59
    v_sub_f32 v58, v37, v56
    v_fma_f32 v59, v58, v58, v59
    v_sub_f32 v58, v38, v56
    v_fma_f32 v59, v58, v58, v59
    v_sub_f32 v58, v39, v56
    v_fma_f32 v59, v58, v58, v59
    v_sub_f32 v58, v40, v56
    v_fma_f32 v59, v58, v58, v59
    v_sub_f32 v58, v41, v56
    v_fma_f32 v59, v58, v58, v59
    v_sub_f32 v58, v42, v56
    v_fma_f32 v59, v58, v58, v59
    v_sub_f32 v58, v43, v56
    v_fma_f32 v59, v58, v58, v59
    v_sub_f32 v58, v44, v56
    v_fma_f32 v59, v58, v58, v59
    v_sub_f32 v58, v45, v56
    v_fma_f32 v59, v58, v58, v59
    v_sub_f32 v58, v46, v56
    v_fma_f32 v59, v58, v58, v59
    v_sub_f32 v58, v47, v56
    v_fma_f32 v59, v58, v58, v59
    v_sub_f32 v58, v48, v56
    v_fma_f32 v59, v58, v58, v59
    v_sub_f32 v58, v49, v56
    v_fma_f32 v59, v58, v58, v59
    v_sub_f32 v58, v50, v56
    v_fma_f32 v59, v58, v58, v59
    v_sub_f32 v58, v51, v56
    v_fma_f32 v59, v58, v58, v59
    v_sub_f32 v58, v52, v56
    v_fma_f32 v59, v58, v58, v59
    v_sub_f32 v58, v53, v56
    v_fma_f32 v59, v58, v58, v59
    v_sub_f32 v58, v54, v56
    v_fma_f32 v59, v58, v58, v59
    v_sub_f32 v58, v55, v56
    v_fma_f32 v59, v58, v58, v59
    s_nop 1
    v_add_f32_dpp v57, v59, v59 row_ror:1 row_mask:0xf bank_mask:0xf
    v_mov_b32 v59, v57
    s_nop 1
    v_add_f32_dpp v57, v59, v59 row_ror:2 row_mask:0xf bank_mask:0xf
    v_mov_b32 v59, v57
    s_nop 1
    v_add_f32_dpp v57, v59, v59 row_ror:4 row_mask:0xf bank_mask:0xf
    v_mov_b32 v59, v57
    s_nop 1
    v_add_f32_dpp v57, v59, v59 row_ror:8 row_mask:0xf bank_mask:0xf
    v_mov_b32 v59, v57
    v_mov_b32 v57, v59
    s_nop 1
    v_permlane16_swap_b32 v59, v57
    s_nop 1
    v_add_f32 v59, v59, v57
    v_mul_f32 v59, 0x3a800000, v59
    v_cvt_pk_bf16_f32 v56, v56, v56
    v_lshlrev_b32 v56, 16, v56
    v_cvt_pk_bf16_f32 v59, v59, v59
    v_lshlrev_b32 v59, 16, v59
    v_add_f32 v59, 0x3727c5ac, v59
    v_cvt_pk_bf16_f32 v59, v59, v59
    v_lshlrev_b32 v59, 16, v59
    v_sqrt_f32 v60, v59
    s_nop 0
    v_rcp_f32 v61, v60
    v_fma_f32 v62, -v60, v60, v59
    v_mul_f32 v61, 0.5, v61
    v_fma_f32 v60, v62, v61, v60
    v_cvt_pk_bf16_f32 v60, v60, v60
    v_lshlrev_b32 v60, 16, v60
    v_rcp_f32 v61, v60
    v_sub_f32 v24, v24, v56
    v_sub_f32 v25, v25, v56
    v_cvt_pk_bf16_f32 v62, v24, v25
    v_lshlrev_b32 v24, 16, v62
    v_and_b32 v25, 0xffff0000, v62
    v_mul_f32 v62, v24, v61
    v_fma_f32 v63, -v62, v60, v24
    v_fma_f32 v24, v63, v61, v62
    v_mul_f32 v62, v25, v61
    v_fma_f32 v63, -v62, v60, v25
    v_fma_f32 v25, v63, v61, v62
    v_cvt_pk_bf16_f32 v8, v24, v25
    v_sub_f32 v26, v26, v56
    v_sub_f32 v27, v27, v56
    v_cvt_pk_bf16_f32 v62, v26, v27
    v_lshlrev_b32 v26, 16, v62
    v_and_b32 v27, 0xffff0000, v62
    v_mul_f32 v62, v26, v61
    v_fma_f32 v63, -v62, v60, v26
    v_fma_f32 v26, v63, v61, v62
    v_mul_f32 v62, v27, v61
    v_fma_f32 v63, -v62, v60, v27
    v_fma_f32 v27, v63, v61, v62
    v_cvt_pk_bf16_f32 v9, v26, v27
    v_sub_f32 v28, v28, v56
    v_sub_f32 v29, v29, v56
    v_cvt_pk_bf16_f32 v62, v28, v29
    v_lshlrev_b32 v28, 16, v62
    v_and_b32 v29, 0xffff0000, v62
    v_mul_f32 v62, v28, v61
    v_fma_f32 v63, -v62, v60, v28
    v_fma_f32 v28, v63, v61, v62
    v_mul_f32 v62, v29, v61
    v_fma_f32 v63, -v62, v60, v29
    v_fma_f32 v29, v63, v61, v62
    v_cvt_pk_bf16_f32 v10, v28, v29
    v_sub_f32 v30, v30, v56
    v_sub_f32 v31, v31, v56
    v_cvt_pk_bf16_f32 v62, v30, v31
    v_lshlrev_b32 v30, 16, v62
    v_and_b32 v31, 0xffff0000, v62
    v_mul_f32 v62, v30, v61
    v_fma_f32 v63, -v62, v60, v30
    v_fma_f32 v30, v63, v61, v62
    v_mul_f32 v62, v31, v61
    v_fma_f32 v63, -v62, v60, v31
    v_fma_f32 v31, v63, v61, v62
    v_cvt_pk_bf16_f32 v11, v30, v31
    v_sub_f32 v32, v32, v56
    v_sub_f32 v33, v33, v56
    v_cvt_pk_bf16_f32 v62, v32, v33
    v_lshlrev_b32 v32, 16, v62
    v_and_b32 v33, 0xffff0000, v62
    v_mul_f32 v62, v32, v61
    v_fma_f32 v63, -v62, v60, v32
    v_fma_f32 v32, v63, v61, v62
    v_mul_f32 v62, v33, v61
    v_fma_f32 v63, -v62, v60, v33
    v_fma_f32 v33, v63, v61, v62
    v_cvt_pk_bf16_f32 v12, v32, v33
    v_sub_f32 v34, v34, v56
    v_sub_f32 v35, v35, v56
    v_cvt_pk_bf16_f32 v62, v34, v35
    v_lshlrev_b32 v34, 16, v62
    v_and_b32 v35, 0xffff0000, v62
    v_mul_f32 v62, v34, v61
    v_fma_f32 v63, -v62, v60, v34
    v_fma_f32 v34, v63, v61, v62
    v_mul_f32 v62, v35, v61
    v_fma_f32 v63, -v62, v60, v35
    v_fma_f32 v35, v63, v61, v62
    v_cvt_pk_bf16_f32 v13, v34, v35
    v_sub_f32 v36, v36, v56
    v_sub_f32 v37, v37, v56
    v_cvt_pk_bf16_f32 v62, v36, v37
    v_lshlrev_b32 v36, 16, v62
    v_and_b32 v37, 0xffff0000, v62
    v_mul_f32 v62, v36, v61
    v_fma_f32 v63, -v62, v60, v36
    v_fma_f32 v36, v63, v61, v62
    v_mul_f32 v62, v37, v61
    v_fma_f32 v63, -v62, v60, v37
    v_fma_f32 v37, v63, v61, v62
    v_cvt_pk_bf16_f32 v14, v36, v37
    v_sub_f32 v38, v38, v56
    v_sub_f32 v39, v39, v56
    v_cvt_pk_bf16_f32 v62, v38, v39
    v_lshlrev_b32 v38, 16, v62
    v_and_b32 v39, 0xffff0000, v62
    v_mul_f32 v62, v38, v61
    v_fma_f32 v63, -v62, v60, v38
    v_fma_f32 v38, v63, v61, v62
    v_mul_f32 v62, v39, v61
    v_fma_f32 v63, -v62, v60, v39
    v_fma_f32 v39, v63, v61, v62
    v_cvt_pk_bf16_f32 v15, v38, v39
    v_sub_f32 v40, v40, v56
    v_sub_f32 v41, v41, v56
    v_cvt_pk_bf16_f32 v62, v40, v41
    v_lshlrev_b32 v40, 16, v62
    v_and_b32 v41, 0xffff0000, v62
    v_mul_f32 v62, v40, v61
    v_fma_f32 v63, -v62, v60, v40
    v_fma_f32 v40, v63, v61, v62
    v_mul_f32 v62, v41, v61
    v_fma_f32 v63, -v62, v60, v41
    v_fma_f32 v41, v63, v61, v62
    v_cvt_pk_bf16_f32 v16, v40, v41
    v_sub_f32 v42, v42, v56
    v_sub_f32 v43, v43, v56
    v_cvt_pk_bf16_f32 v62, v42, v43
    v_lshlrev_b32 v42, 16, v62
    v_and_b32 v43, 0xffff0000, v62
    v_mul_f32 v62, v42, v61
    v_fma_f32 v63, -v62, v60, v42
    v_fma_f32 v42, v63, v61, v62
    v_mul_f32 v62, v43, v61
    v_fma_f32 v63, -v62, v60, v43
    v_fma_f32 v43, v63, v61, v62
    v_cvt_pk_bf16_f32 v17, v42, v43
    v_sub_f32 v44, v44, v56
    v_sub_f32 v45, v45, v56
    v_cvt_pk_bf16_f32 v62, v44, v45
    v_lshlrev_b32 v44, 16, v62
    v_and_b32 v45, 0xffff0000, v62
    v_mul_f32 v62, v44, v61
    v_fma_f32 v63, -v62, v60, v44
    v_fma_f32 v44, v63, v61, v62
    v_mul_f32 v62, v45, v61
    v_fma_f32 v63, -v62, v60, v45
    v_fma_f32 v45, v63, v61, v62
    v_cvt_pk_bf16_f32 v18, v44, v45
    v_sub_f32 v46, v46, v56
    v_sub_f32 v47, v47, v56
    v_cvt_pk_bf16_f32 v62, v46, v47
    v_lshlrev_b32 v46, 16, v62
    v_and_b32 v47, 0xffff0000, v62
    v_mul_f32 v62, v46, v61
    v_fma_f32 v63, -v62, v60, v46
    v_fma_f32 v46, v63, v61, v62
    v_mul_f32 v62, v47, v61
    v_fma_f32 v63, -v62, v60, v47
    v_fma_f32 v47, v63, v61, v62
    v_cvt_pk_bf16_f32 v19, v46, v47
    v_sub_f32 v48, v48, v56
    v_sub_f32 v49, v49, v56
    v_cvt_pk_bf16_f32 v62, v48, v49
    v_lshlrev_b32 v48, 16, v62
    v_and_b32 v49, 0xffff0000, v62
    v_mul_f32 v62, v48, v61
    v_fma_f32 v63, -v62, v60, v48
    v_fma_f32 v48, v63, v61, v62
    v_mul_f32 v62, v49, v61
    v_fma_f32 v63, -v62, v60, v49
    v_fma_f32 v49, v63, v61, v62
    v_cvt_pk_bf16_f32 v20, v48, v49
    v_sub_f32 v50, v50, v56
    v_sub_f32 v51, v51, v56
    v_cvt_pk_bf16_f32 v62, v50, v51
    v_lshlrev_b32 v50, 16, v62
    v_and_b32 v51, 0xffff0000, v62
    v_mul_f32 v62, v50, v61
    v_fma_f32 v63, -v62, v60, v50
    v_fma_f32 v50, v63, v61, v62
    v_mul_f32 v62, v51, v61
    v_fma_f32 v63, -v62, v60, v51
    v_fma_f32 v51, v63, v61, v62
    v_cvt_pk_bf16_f32 v21, v50, v51
    v_sub_f32 v52, v52, v56
    v_sub_f32 v53, v53, v56
    v_cvt_pk_bf16_f32 v62, v52, v53
    v_lshlrev_b32 v52, 16, v62
    v_and_b32 v53, 0xffff0000, v62
    v_mul_f32 v62, v52, v61
    v_fma_f32 v63, -v62, v60, v52
    v_fma_f32 v52, v63, v61, v62
    v_mul_f32 v62, v53, v61
    v_fma_f32 v63, -v62, v60, v53
    v_fma_f32 v53, v63, v61, v62
    v_cvt_pk_bf16_f32 v22, v52, v53
    v_sub_f32 v54, v54, v56
    v_sub_f32 v55, v55, v56
    v_cvt_pk_bf16_f32 v62, v54, v55
    v_lshlrev_b32 v54, 16, v62
    v_and_b32 v55, 0xffff0000, v62
    v_mul_f32 v62, v54, v61
    v_fma_f32 v63, -v62, v60, v54
    v_fma_f32 v54, v63, v61, v62
    v_mul_f32 v62, v55, v61
    v_fma_f32 v63, -v62, v60, v55
    v_fma_f32 v55, v63, v61, v62
    v_cvt_pk_bf16_f32 v23, v54, v55
    ds_write_b128 v1, v[8:11] offset:0
    ds_write_b128 v1, v[12:15] offset:16
    ds_write_b128 v1, v[16:19] offset:32
    ds_write_b128 v1, v[20:23] offset:48
    s_waitcnt lgkmcnt(0)
    v_mov_b32 v6, 6752
    v_mov_b32 v7, 1
    s_mov_b64 exec, 1
    ds_write_b32 v6, v7
    s_mov_b64 exec, -1
    v_mov_b32 v6, 6744
    s_mov_b32 s51, 4000000
LW_1:
    ds_read_b32 v7, v6
    s_waitcnt lgkmcnt(0)
    v_readfirstlane_b32 s50, v7
    s_cmp_ge_u32 s50, 1
    s_cbranch_scc1 LWD_2
    s_sleep 1
    s_sub_u32 s51, s51, 1
    s_cmp_lg_u32 s51, 0
    s_cbranch_scc1 LW_1
LWD_2:
    s_mov_b32 s55, s50
    s_lshr_b32 s44, s86, 5
    s_lshl_b32 s44, s44, 15
    s_add_u32 s44, s44, 16384
    s_lshr_b32 s45, s44, 1
    s_add_u32 s45, s45, 3145728
    s_lshr_b32 s48, s86, 6
    s_add_u32 s48, s48, 1
    s_lshl_b32 s46, s48, 7
    s_add_u32 s46, s46, 2883584
    v_mov_b32 v6, 0
    s_mov_b32 s51, 40000
    s_mov_b64 exec, 1
FW_3:
    buffer_load_dword v7, v6, s[36:39], s46 offen sc1
    s_waitcnt vmcnt(0)
    v_readfirstlane_b32 s50, v7
    s_cmp_eq_u32 s50, s55
    s_cbranch_scc1 FWD_4
    s_sleep 4
    s_sub_u32 s51, s51, 1
    s_cmp_lg_u32 s51, 0
    s_cbranch_scc1 FW_3
FWD_4:
    s_mov_b64 exec, -1
    v_lshrrev_b32 v2, 5, v0
    v_lshlrev_b32 v2, 12, v2
    v_and_b32 v3, 31, v0
    v_lshl_add_u32 v2, v3, 4, v2
    v_lshrrev_b32 v3, 1, v2
    v_lshrrev_b32 v8, 5, v0
    v_lshlrev_b32 v8, 8, v8
    v_bfe_u32 v9, v0, 3, 2
    v_lshlrev_b32 v9, 6, v9
    v_and_b32 v10, 7, v0
    v_lshlrev_b32 v10, 1, v10
    v_add3_u32 v8, v8, v9, v10
    s_add_u32 s46, s44, 0
    s_add_u32 s48, s45, 0
    buffer_load_dwordx4 v[40:43], v2, s[36:39], s46 offen offset:0
    buffer_load_dwordx2 v[104:105], v3, s[36:39], s48 offen offset:0
    buffer_load_dwordx4 v[44:47], v2, s[36:39], s46 offen offset:512
    buffer_load_dwordx2 v[106:107], v3, s[36:39], s48 offen offset:256
    buffer_load_dwordx4 v[48:51], v2, s[36:39], s46 offen offset:1024
    buffer_load_dwordx2 v[108:109], v3, s[36:39], s48 offen offset:512
    buffer_load_dwordx4 v[52:55], v2, s[36:39], s46 offen offset:1536
    buffer_load_dwordx2 v[110:111], v3, s[36:39], s48 offen offset:768
    buffer_load_dwordx4 v[56:59], v2, s[36:39], s46 offen offset:2048
    buffer_load_dwordx2 v[112:113], v3, s[36:39], s48 offen offset:1024
    buffer_load_dwordx4 v[60:63], v2, s[36:39], s46 offen offset:2560
    buffer_load_dwordx2 v[114:115], v3, s[36:39], s48 offen offset:1280
    buffer_load_dwordx4 v[64:67], v2, s[36:39], s46 offen offset:3072
    buffer_load_dwordx2 v[116:117], v3, s[36:39], s48 offen offset:1536
    buffer_load_dwordx4 v[68:71], v2, s[36:39], s46 offen offset:3584
    buffer_load_dwordx2 v[118:119], v3, s[36:39], s48 offen offset:1792
    s_add_u32 s46, s44, 8192
    s_add_u32 s48, s45, 4096
    buffer_load_dwordx4 v[72:75], v2, s[36:39], s46 offen offset:0
    buffer_load_dwordx2 v[120:121], v3, s[36:39], s48 offen offset:0
    buffer_load_dwordx4 v[76:79], v2, s[36:39], s46 offen offset:512
    buffer_load_dwordx2 v[122:123], v3, s[36:39], s48 offen offset:256
    buffer_load_dwordx4 v[80:83], v2, s[36:39], s46 offen offset:1024
    buffer_load_dwordx2 v[124:125], v3, s[36:39], s48 offen offset:512
    buffer_load_dwordx4 v[84:87], v2, s[36:39], s46 offen offset:1536
    buffer_load_dwordx2 v[126:127], v3, s[36:39], s48 offen offset:768
    buffer_load_dwordx4 v[88:91], v2, s[36:39], s46 offen offset:2048
    buffer_load_dwordx2 v[128:129], v3, s[36:39], s48 offen offset:1024
    buffer_load_dwordx4 v[92:95], v2, s[36:39], s46 offen offset:2560
    buffer_load_dwordx2 v[130:131], v3, s[36:39], s48 offen offset:1280
    buffer_load_dwordx4 v[96:99], v2, s[36:39], s46 offen offset:3072
    buffer_load_dwordx2 v[132:133], v3, s[36:39], s48 offen offset:1536
    buffer_load_dwordx4 v[100:103], v2, s[36:39], s46 offen offset:3584
    buffer_load_dwordx2 v[134:135], v3, s[36:39], s48 offen offset:1792
    s_waitcnt vmcnt(0)
    v_xor_b32 v7, s55, v43
    v_xor_b32 v6, s55, v47
    v_or_b32 v7, v7, v6
    v_xor_b32 v6, s55, v51
    v_or_b32 v7, v7, v6
    v_xor_b32 v6, s55, v55
    v_or_b32 v7, v7, v6
    v_xor_b32 v6, s55, v59
    v_or_b32 v7, v7, v6
    v_xor_b32 v6, s55, v63
    v_or_b32 v7, v7, v6
    v_xor_b32 v6, s55, v67
    v_or_b32 v7, v7, v6
    v_xor_b32 v6, s55, v71
    v_or_b32 v7, v7, v6
    v_xor_b32 v6, s55, v75
    v_or_b32 v7, v7, v6
    v_xor_b32 v6, s55, v79
    v_or_b32 v7, v7, v6
    v_xor_b32 v6, s55, v83
    v_or_b32 v7, v7, v6
    v_xor_b32 v6, s55, v87
    v_or_b32 v7, v7, v6
    v_xor_b32 v6, s55, v91
    v_or_b32 v7, v7, v6
    v_xor_b32 v6, s55, v95
    v_or_b32 v7, v7, v6
    v_xor_b32 v6, s55, v99
    v_or_b32 v7, v7, v6
    v_xor_b32 v6, s55, v103
    v_or_b32 v7, v7, v6
    v_xor_b32 v6, s55, v105
    v_or_b32 v7, v7, v6
    v_xor_b32 v6, s55, v107
    v_or_b32 v7, v7, v6
    v_xor_b32 v6, s55, v109
    v_or_b32 v7, v7, v6
    v_xor_b32 v6, s55, v111
    v_or_b32 v7, v7, v6
    v_xor_b32 v6, s55, v113
    v_or_b32 v7, v7, v6
    v_xor_b32 v6, s55, v115
    v_or_b32 v7, v7, v6
    v_xor_b32 v6, s55, v117
    v_or_b32 v7, v7, v6
    v_xor_b32 v6, s55, v119
    v_or_b32 v7, v7, v6
    v_xor_b32 v6, s55, v121
    v_or_b32 v7, v7, v6
    v_xor_b32 v6, s55, v123
    v_or_b32 v7, v7, v6
    v_xor_b32 v6, s55, v125
    v_or_b32 v7, v7, v6
    v_xor_b32 v6, s55, v127
    v_or_b32 v7, v7, v6
    v_xor_b32 v6, s55, v129
    v_or_b32 v7, v7, v6
    v_xor_b32 v6, s55, v131
    v_or_b32 v7, v7, v6
    v_xor_b32 v6, s55, v133
    v_or_b32 v7, v7, v6
    v_xor_b32 v6, s55, v135
    v_or_b32 v7, v7, v6
    v_cmp_ne_u32 vcc, 0, v7
    s_cbranch_vccz TPD_6
    s_mov_b32 s51, 40000
TP_5:
    s_add_u32 s46, s44, 0
    s_add_u32 s48, s45, 0
    buffer_load_dwordx4 v[40:43], v2, s[36:39], s46 offen offset:0 sc1
    buffer_load_dwordx2 v[104:105], v3, s[36:39], s48 offen offset:0 sc1
    buffer_load_dwordx4 v[44:47], v2, s[36:39], s46 offen offset:512 sc1
    buffer_load_dwordx2 v[106:107], v3, s[36:39], s48 offen offset:256 sc1
    buffer_load_dwordx4 v[48:51], v2, s[36:39], s46 offen offset:1024 sc1
    buffer_load_dwordx2 v[108:109], v3, s[36:39], s48 offen offset:512 sc1
    buffer_load_dwordx4 v[52:55], v2, s[36:39], s46 offen offset:1536 sc1
    buffer_load_dwordx2 v[110:111], v3, s[36:39], s48 offen offset:768 sc1
    buffer_load_dwordx4 v[56:59], v2, s[36:39], s46 offen offset:2048 sc1
    buffer_load_dwordx2 v[112:113], v3, s[36:39], s48 offen offset:1024 sc1
    buffer_load_dwordx4 v[60:63], v2, s[36:39], s46 offen offset:2560 sc1
    buffer_load_dwordx2 v[114:115], v3, s[36:39], s48 offen offset:1280 sc1
    buffer_load_dwordx4 v[64:67], v2, s[36:39], s46 offen offset:3072 sc1
    buffer_load_dwordx2 v[116:117], v3, s[36:39], s48 offen offset:1536 sc1
    buffer_load_dwordx4 v[68:71], v2, s[36:39], s46 offen offset:3584 sc1
    buffer_load_dwordx2 v[118:119], v3, s[36:39], s48 offen offset:1792 sc1
    s_add_u32 s46, s44, 8192
    s_add_u32 s48, s45, 4096
    buffer_load_dwordx4 v[72:75], v2, s[36:39], s46 offen offset:0 sc1
    buffer_load_dwordx2 v[120:121], v3, s[36:39], s48 offen offset:0 sc1
    buffer_load_dwordx4 v[76:79], v2, s[36:39], s46 offen offset:512 sc1
    buffer_load_dwordx2 v[122:123], v3, s[36:39], s48 offen offset:256 sc1
    buffer_load_dwordx4 v[80:83], v2, s[36:39], s46 offen offset:1024 sc1
    buffer_load_dwordx2 v[124:125], v3, s[36:39], s48 offen offset:512 sc1
    buffer_load_dwordx4 v[84:87], v2, s[36:39], s46 offen offset:1536 sc1
    buffer_load_dwordx2 v[126:127], v3, s[36:39], s48 offen offset:768 sc1
    buffer_load_dwordx4 v[88:91], v2, s[36:39], s46 offen offset:2048 sc1
    buffer_load_dwordx2 v[128:129], v3, s[36:39], s48 offen offset:1024 sc1
    buffer_load_dwordx4 v[92:95], v2, s[36:39], s46 offen offset:2560 sc1
    buffer_load_dwordx2 v[130:131], v3, s[36:39], s48 offen offset:1280 sc1
    buffer_load_dwordx4 v[96:99], v2, s[36:39], s46 offen offset:3072 sc1
    buffer_load_dwordx2 v[132:133], v3, s[36:39], s48 offen offset:1536 sc1
    buffer_load_dwordx4 v[100:103], v2, s[36:39], s46 offen offset:3584 sc1
    buffer_load_dwordx2 v[134:135], v3, s[36:39], s48 offen offset:1792 sc1
    s_waitcnt vmcnt(0)
    v_xor_b32 v7, s55, v43
    v_xor_b32 v6, s55, v47
    v_or_b32 v7, v7, v6
    v_xor_b32 v6, s55, v51
    v_or_b32 v7, v7, v6
    v_xor_b32 v6, s55, v55
    v_or_b32 v7, v7, v6
    v_xor_b32 v6, s55, v59
    v_or_b32 v7, v7, v6
    v_xor_b32 v6, s55, v63
    v_or_b32 v7, v7, v6
    v_xor_b32 v6, s55, v67
    v_or_b32 v7, v7, v6
    v_xor_b32 v6, s55, v71
    v_or_b32 v7, v7, v6
    v_xor_b32 v6, s55, v75
    v_or_b32 v7, v7, v6
    v_xor_b32 v6, s55, v79
    v_or_b32 v7, v7, v6
    v_xor_b32 v6, s55, v83
    v_or_b32 v7, v7, v6
    v_xor_b32 v6, s55, v87
    v_or_b32 v7, v7, v6
    v_xor_b32 v6, s55, v91
    v_or_b32 v7, v7, v6
    v_xor_b32 v6, s55, v95
    v_or_b32 v7, v7, v6
    v_xor_b32 v6, s55, v99
    v_or_b32 v7, v7, v6
    v_xor_b32 v6, s55, v103
    v_or_b32 v7, v7, v6
    v_xor_b32 v6, s55, v105
    v_or_b32 v7, v7, v6
    v_xor_b32 v6, s55, v107
    v_or_b32 v7, v7, v6
    v_xor_b32 v6, s55, v109
    v_or_b32 v7, v7, v6
    v_xor_b32 v6, s55, v111
    v_or_b32 v7, v7, v6
    v_xor_b32 v6, s55, v113
    v_or_b32 v7, v7, v6
    v_xor_b32 v6, s55, v115
    v_or_b32 v7, v7, v6
    v_xor_b32 v6, s55, v117
    v_or_b32 v7, v7, v6
    v_xor_b32 v6, s55, v119
    v_or_b32 v7, v7, v6
    v_xor_b32 v6, s55, v121
    v_or_b32 v7, v7, v6
    v_xor_b32 v6, s55, v123
    v_or_b32 v7, v7, v6
    v_xor_b32 v6, s55, v125
    v_or_b32 v7, v7, v6
    v_xor_b32 v6, s55, v127
    v_or_b32 v7, v7, v6
    v_xor_b32 v6, s55, v129
    v_or_b32 v7, v7, v6
    v_xor_b32 v6, s55, v131
    v_or_b32 v7, v7, v6
    v_xor_b32 v6, s55, v133
    v_or_b32 v7, v7, v6
    v_xor_b32 v6, s55, v135
    v_or_b32 v7, v7, v6
    v_cmp_ne_u32 vcc, 0, v7
    s_cbranch_vccz TPD_6
    s_sleep 4
    s_sub_u32 s51, s51, 1
    s_cmp_lg_u32 s51, 0
    s_cbranch_scc1 TP_5
TPD_6:
    v_add_f32 v12, v40, v44
    v_add_f32 v12, v12, v48
    v_add_f32 v12, v12, v52
    v_add_f32 v12, v12, v56
    v_add_f32 v12, v12, v60
    v_add_f32 v12, v12, v64
    v_add_f32 v12, v12, v68
    v_add_f32 v13, v41, v45
    v_add_f32 v13, v13, v49
    v_add_f32 v13, v13, v53
    v_add_f32 v13, v13, v57
    v_add_f32 v13, v13, v61
    v_add_f32 v13, v13, v65
    v_add_f32 v13, v13, v69
    v_add_f32 v14, v42, v46
    v_add_f32 v14, v14, v50
    v_add_f32 v14, v14, v54
    v_add_f32 v14, v14, v58
    v_add_f32 v14, v14, v62
    v_add_f32 v14, v14, v66
    v_add_f32 v14, v14, v70
    v_add_f32 v15, v104, v106
    v_add_f32 v15, v15, v108
    v_add_f32 v15, v15, v110
    v_add_f32 v15, v15, v112
    v_add_f32 v15, v15, v114
    v_add_f32 v15, v15, v116
    v_add_f32 v15, v15, v118
    v_cvt_pk_bf16_f32 v12, v12, v13
    v_cvt_pk_bf16_f32 v14, v14, v15
    ds_write_b16 v8, v12 offset:5120
    ds_write_b16_d16_hi v8, v12 offset:5136
    ds_write_b16 v8, v14 offset:5152
    ds_write_b16_d16_hi v8, v14 offset:5168
    v_add_f32 v12, v72, v76
    v_add_f32 v12, v12, v80
    v_add_f32 v12, v12, v84
    v_add_f32 v12, v12, v88
    v_add_f32 v12, v12, v92
    v_add_f32 v12, v12, v96
    v_add_f32 v12, v12, v100
    v_add_f32 v13, v73, v77
    v_add_f32 v13, v13, v81
    v_add_f32 v13, v13, v85
    v_add_f32 v13, v13, v89
    v_add_f32 v13, v13, v93
    v_add_f32 v13, v13, v97
    v_add_f32 v13, v13, v101
    v_add_f32 v14, v74, v78
    v_add_f32 v14, v14, v82
    v_add_f32 v14, v14, v86
    v_add_f32 v14, v14, v90
    v_add_f32 v14, v14, v94
    v_add_f32 v14, v14, v98
    v_add_f32 v14, v14, v102
    v_add_f32 v15, v120, v122
    v_add_f32 v15, v15, v124
    v_add_f32 v15, v15, v126
    v_add_f32 v15, v15, v128
    v_add_f32 v15, v15, v130
    v_add_f32 v15, v15, v132
    v_add_f32 v15, v15, v134
    v_cvt_pk_bf16_f32 v12, v12, v13
    v_cvt_pk_bf16_f32 v14, v14, v15
    ds_write_b16 v8, v12 offset:5632
    ds_write_b16_d16_hi v8, v12 offset:5648
    ds_write_b16 v8, v14 offset:5664
    ds_write_b16_d16_hi v8, v14 offset:5680
    s_waitcnt lgkmcnt(0)
    v_mov_b32 v6, 6720
    v_mov_b32 v7, 1
    s_mov_b64 exec, 1
    ds_add_u32 v6, v7
    s_mov_b64 exec, -1
    v_mov_b32 v6, 6720
    s_mov_b32 s51, 4000000
LW_7:
    ds_read_b32 v7, v6
    s_waitcnt lgkmcnt(0)
    v_readfirstlane_b32 s50, v7
    s_cmp_ge_u32 s50, 2
    s_cbranch_scc1 LWD_8
    s_sleep 1
    s_sub_u32 s51, s51, 1
    s_cmp_lg_u32 s51, 0
    s_cbranch_scc1 LW_7
LWD_8:
    s_mov_b32 s63, s55
    v_mov_b32 v6, 0
    s_mov_b32 s51, 40000
    s_mov_b64 exec, 1
CW_9:
    buffer_load_dword v7, v6, s[40:43], 0 offen sc1
    s_waitcnt vmcnt(0)
    v_readfirstlane_b32 s50, v7
    s_cmp_ge_u32 s50, 1
    s_cbranch_scc1 CWD_10
    s_sleep 8
    s_sub_u32 s51, s51, 1
    s_cmp_lg_u32 s51, 0
    s_cbranch_scc1 CW_9
CWD_10:
    s_mov_b64 exec, -1
    s_mov_b32 s55, s50
    s_cmp_lt_u32 s89, 32
    s_cbranch_scc1 L_A3_OG
    s_sub_u32 s44, s89, 32
    s_lshr_b32 s44, s44, 3
    s_lshl_b32 s44, s44, 14
    s_add_u32 s44, s44, 262144
    s_lshr_b32 s45, s44, 1
    s_add_u32 s45, s45, 3145728
    v_lshlrev_b32 v1, 4, v0
    v_lshlrev_b32 v2, 3, v0
    s_sub_u32 s48, s89, 32
    s_lshr_b32 s48, s48, 3
    s_add_u32 s48, s48, 16
    s_lshl_b32 s46, s48, 7
    s_add_u32 s46, s46, 2883584
    v_mov_b32 v6, 0
    s_mov_b32 s51, 40000
    s_mov_b64 exec, 1
FW_11:
    buffer_load_dword v7, v6, s[36:39], s46 offen sc1
    s_waitcnt vmcnt(0)
    v_readfirstlane_b32 s50, v7
    s_cmp_eq_u32 s50, s55
    s_cbranch_scc1 FWD_12
    s_sleep 32
    s_sub_u32 s51, s51, 1
    s_cmp_lg_u32 s51, 0
    s_cbranch_scc1 FW_11
FWD_12:
    s_mov_b64 exec, -1
    s_add_u32 s46, s44, 0
    buffer_load_dwordx4 v[72:75], v1, s[36:39], s46 offen
    buffer_load_dwordx4 v[104:107], v1, s[36:39], s46 offen offset:1024
    s_add_u32 s46, s44, 2048
    buffer_load_dwordx4 v[76:79], v1, s[36:39], s46 offen
    buffer_load_dwordx4 v[108:111], v1, s[36:39], s46 offen offset:1024
    s_add_u32 s46, s44, 4096
    buffer_load_dwordx4 v[80:83], v1, s[36:39], s46 offen
    buffer_load_dwordx4 v[112:115], v1, s[36:39], s46 offen offset:1024
    s_add_u32 s46, s44, 6144
    buffer_load_dwordx4 v[84:87], v1, s[36:39], s46 offen
    buffer_load_dwordx4 v[116:119], v1, s[36:39], s46 offen offset:1024
    s_add_u32 s46, s44, 8192
    buffer_load_dwordx4 v[88:91], v1, s[36:39], s46 offen
    buffer_load_dwordx4 v[120:123], v1, s[36:39], s46 offen offset:1024
    s_add_u32 s46, s44, 10240
    buffer_load_dwordx4 v[92:95], v1, s[36:39], s46 offen
    buffer_load_dwordx4 v[124:127], v1, s[36:39], s46 offen offset:1024
    s_add_u32 s46, s44, 12288
    buffer_load_dwordx4 v[96:99], v1, s[36:39], s46 offen
    buffer_load_dwordx4 v[128:131], v1, s[36:39], s46 offen offset:1024
    s_add_u32 s46, s44, 14336
    buffer_load_dwordx4 v[100:103], v1, s[36:39], s46 offen
    buffer_load_dwordx4 v[132:135], v1, s[36:39], s46 offen offset:1024
    s_waitcnt vmcnt(0)
    v_xor_b32 v7, s55, v75
    v_xor_b32 v6, s55, v79
    v_or_b32 v7, v7, v6
    v_xor_b32 v6, s55, v83
    v_or_b32 v7, v7, v6
    v_xor_b32 v6, s55, v87
    v_or_b32 v7, v7, v6
    v_xor_b32 v6, s55, v91
    v_or_b32 v7, v7, v6
    v_xor_b32 v6, s55, v95
    v_or_b32 v7, v7, v6
    v_xor_b32 v6, s55, v99
    v_or_b32 v7, v7, v6
    v_xor_b32 v6, s55, v103
    v_or_b32 v7, v7, v6
    v_xor_b32 v6, s55, v107
    v_or_b32 v7, v7, v6
    v_xor_b32 v6, s55, v111
    v_or_b32 v7, v7, v6
    v_xor_b32 v6, s55, v115
    v_or_b32 v7, v7, v6
    v_xor_b32 v6, s55, v119
    v_or_b32 v7, v7, v6
    v_xor_b32 v6, s55, v123
    v_or_b32 v7, v7, v6
    v_xor_b32 v6, s55, v127
    v_or_b32 v7, v7, v6
    v_xor_b32 v6, s55, v131
    v_or_b32 v7, v7, v6
    v_xor_b32 v6, s55, v135
    v_or_b32 v7, v7, v6
    v_cmp_ne_u32 vcc, 0, v7
    s_cbranch_vccz TPD_14
    s_mov_b32 s51, 40000
TP_13:
    s_add_u32 s46, s44, 0
    buffer_load_dwordx4 v[72:75], v1, s[36:39], s46 offen sc1
    buffer_load_dwordx4 v[104:107], v1, s[36:39], s46 offen offset:1024 sc1
    s_add_u32 s46, s44, 2048
    buffer_load_dwordx4 v[76:79], v1, s[36:39], s46 offen sc1
    buffer_load_dwordx4 v[108:111], v1, s[36:39], s46 offen offset:1024 sc1
    s_add_u32 s46, s44, 4096
    buffer_load_dwordx4 v[80:83], v1, s[36:39], s46 offen sc1
    buffer_load_dwordx4 v[112:115], v1, s[36:39], s46 offen offset:1024 sc1
    s_add_u32 s46, s44, 6144
    buffer_load_dwordx4 v[84:87], v1, s[36:39], s46 offen sc1
    buffer_load_dwordx4 v[116:119], v1, s[36:39], s46 offen offset:1024 sc1
    s_add_u32 s46, s44, 8192
    buffer_load_dwordx4 v[88:91], v1, s[36:39], s46 offen sc1
    buffer_load_dwordx4 v[120:123], v1, s[36:39], s46 offen offset:1024 sc1
    s_add_u32 s46, s44, 10240
    buffer_load_dwordx4 v[92:95], v1, s[36:39], s46 offen sc1
    buffer_load_dwordx4 v[124:127], v1, s[36:39], s46 offen offset:1024 sc1
    s_add_u32 s46, s44, 12288
    buffer_load_dwordx4 v[96:99], v1, s[36:39], s46 offen sc1
    buffer_load_dwordx4 v[128:131], v1, s[36:39], s46 offen offset:1024 sc1
    s_add_u32 s46, s44, 14336
    buffer_load_dwordx4 v[100:103], v1, s[36:39], s46 offen sc1
    buffer_load_dwordx4 v[132:135], v1, s[36:39], s46 offen offset:1024 sc1
    s_waitcnt vmcnt(0)
    v_xor_b32 v7, s55, v75
    v_xor_b32 v6, s55, v79
    v_or_b32 v7, v7, v6
    v_xor_b32 v6, s55, v83
    v_or_b32 v7, v7, v6
    v_xor_b32 v6, s55, v87
    v_or_b32 v7, v7, v6
    v_xor_b32 v6, s55, v91
    v_or_b32 v7, v7, v6
    v_xor_b32 v6, s55, v95
    v_or_b32 v7, v7, v6
    v_xor_b32 v6, s55, v99
    v_or_b32 v7, v7, v6
    v_xor_b32 v6, s55, v103
    v_or_b32 v7, v7, v6
    v_xor_b32 v6, s55, v107
    v_or_b32 v7, v7, v6
    v_xor_b32 v6, s55, v111
    v_or_b32 v7, v7, v6
    v_xor_b32 v6, s55, v115
    v_or_b32 v7, v7, v6
    v_xor_b32 v6, s55, v119
    v_or_b32 v7, v7, v6
    v_xor_b32 v6, s55, v123
    v_or_b32 v7, v7, v6
    v_xor_b32 v6, s55, v127
    v_or_b32 v7, v7, v6
    v_xor_b32 v6, s55, v131
    v_or_b32 v7, v7, v6
    v_xor_b32 v6, s55, v135
    v_or_b32 v7, v7, v6
    v_cmp_ne_u32 vcc, 0, v7
    s_cbranch_vccz TPD_14
    s_sleep 16
    s_sub_u32 s51, s51, 1
    s_cmp_lg_u32 s51, 0
    s_cbranch_scc1 TP_13
TPD_14:
    v_perm_b32 v75, v72, v73, s93
    v_perm_b32 v75, v75, v74, s94
    v_perm_b32 v79, v76, v77, s93
    v_perm_b32 v79, v79, v78, s94
    v_perm_b32 v83, v80, v81, s93
    v_perm_b32 v83, v83, v82, s94
    v_perm_b32 v87, v84, v85, s93
    v_perm_b32 v87, v87, v86, s94
    v_perm_b32 v91, v88, v89, s93
    v_perm_b32 v91, v91, v90, s94
    v_perm_b32 v95, v92, v93, s93
    v_perm_b32 v95, v95, v94, s94
    v_perm_b32 v99, v96, v97, s93
    v_perm_b32 v99, v99, v98, s94
    v_perm_b32 v103, v100, v101, s93
    v_perm_b32 v103, v103, v102, s94
    v_perm_b32 v107, v104, v105, s93
    v_perm_b32 v107, v107, v106, s94
    v_perm_b32 v111, v108, v109, s93
    v_perm_b32 v111, v111, v110, s94
    v_perm_b32 v115, v112, v113, s93
    v_perm_b32 v115, v115, v114, s94
    v_perm_b32 v119, v116, v117, s93
    v_perm_b32 v119, v119, v118, s94
    v_perm_b32 v123, v120, v121, s93
    v_perm_b32 v123, v123, v122, s94
    v_perm_b32 v127, v124, v125, s93
    v_perm_b32 v127, v127, v126, s94
    v_perm_b32 v131, v128, v129, s93
    v_perm_b32 v131, v131, v130, s94
    v_perm_b32 v135, v132, v133, s93
    v_perm_b32 v135, v135, v134, s94
    v_add_f32 v8, v72, v76
    v_add_f32 v12, v104, v108
    v_add_f32 v8, v8, v80
    v_add_f32 v12, v12, v112
    v_add_f32 v8, v8, v84
    v_add_f32 v12, v12, v116
    v_add_f32 v8, v8, v88
    v_add_f32 v12, v12, v120
    v_add_f32 v8, v8, v92
    v_add_f32 v12, v12, v124
    v_add_f32 v8, v8, v96
    v_add_f32 v12, v12, v128
    v_add_f32 v8, v8, v100
    v_add_f32 v12, v12, v132
    v_add_f32 v9, v73, v77
    v_add_f32 v13, v105, v109
    v_add_f32 v9, v9, v81
    v_add_f32 v13, v13, v113
    v_add_f32 v9, v9, v85
    v_add_f32 v13, v13, v117
    v_add_f32 v9, v9, v89
    v_add_f32 v13, v13, v121
    v_add_f32 v9, v9, v93
    v_add_f32 v13, v13, v125
    v_add_f32 v9, v9, v97
    v_add_f32 v13, v13, v129
    v_add_f32 v9, v9, v101
    v_add_f32 v13, v13, v133
    v_add_f32 v10, v74, v78
    v_add_f32 v14, v106, v110
    v_add_f32 v10, v10, v82
    v_add_f32 v14, v14, v114
    v_add_f32 v10, v10, v86
    v_add_f32 v14, v14, v118
    v_add_f32 v10, v10, v90
    v_add_f32 v14, v14, v122
    v_add_f32 v10, v10, v94
    v_add_f32 v14, v14, v126
    v_add_f32 v10, v10, v98
    v_add_f32 v14, v14, v130
    v_add_f32 v10, v10, v102
    v_add_f32 v14, v14, v134
    v_add_f32 v11, v75, v79
    v_add_f32 v15, v107, v111
    v_add_f32 v11, v11, v83
    v_add_f32 v15, v15, v115
    v_add_f32 v11, v11, v87
    v_add_f32 v15, v15, v119
    v_add_f32 v11, v11, v91
    v_add_f32 v15, v15, v123
    v_add_f32 v11, v11, v95
    v_add_f32 v15, v15, v127
    v_add_f32 v11, v11, v99
    v_add_f32 v15, v15, v131
    v_add_f32 v11, v11, v103
    v_add_f32 v15, v15, v135
    v_cvt_pk_bf16_f32 v16, v8, v9
    v_lshlrev_b32 v8, 16, v16
    v_and_b32 v9, 0xffff0000, v16
    v_cvt_pk_bf16_f32 v16, v10, v11
    v_lshlrev_b32 v10, 16, v16
    v_and_b32 v11, 0xffff0000, v16
    v_cvt_pk_bf16_f32 v16, v12, v13
    v_lshlrev_b32 v12, 16, v16
    v_and_b32 v13, 0xffff0000, v16
    v_cvt_pk_bf16_f32 v16, v14, v15
    v_lshlrev_b32 v14, 16, v16
    v_and_b32 v15, 0xffff0000, v16
    v_mul_f32 v16, s60, v8
    v_exp_f32 v16, -v16
    s_nop 0
    v_add_f32 v16, 1.0, v16
    v_rcp_f32 v17, v16
    s_nop 0
    v_mul_f32 v18, v8, v17
    v_fma_f32 v16, -v18, v16, v8
    v_fma_f32 v16, v16, v17, v18
    v_cmp_eq_f32 vcc, 0, v17
    s_nop 1
    v_cndmask_b32 v8, v16, v18, vcc
    v_mul_f32 v16, s60, v9
    v_exp_f32 v16, -v16
    s_nop 0
    v_add_f32 v16, 1.0, v16
    v_rcp_f32 v17, v16
    s_nop 0
    v_mul_f32 v18, v9, v17
    v_fma_f32 v16, -v18, v16, v9
    v_fma_f32 v16, v16, v17, v18
    v_cmp_eq_f32 vcc, 0, v17
    s_nop 1
    v_cndmask_b32 v9, v16, v18, vcc
    v_mul_f32 v16, s60, v10
    v_exp_f32 v16, -v16
    s_nop 0
    v_add_f32 v16, 1.0, v16
    v_rcp_f32 v17, v16
    s_nop 0
    v_mul_f32 v18, v10, v17
    v_fma_f32 v16, -v18, v16, v10
    v_fma_f32 v16, v16, v17, v18
    v_cmp_eq_f32 vcc, 0, v17
    s_nop 1
    v_cndmask_b32 v10, v16, v18, vcc
    v_mul_f32 v16, s60, v11
    v_exp_f32 v16, -v16
    s_nop 0
    v_add_f32 v16, 1.0, v16
    v_rcp_f32 v17, v16
    s_nop 0
    v_mul_f32 v18, v11, v17
    v_fma_f32 v16, -v18, v16, v11
    v_fma_f32 v16, v16, v17, v18
    v_cmp_eq_f32 vcc, 0, v17
    s_nop 1
    v_cndmask_b32 v11, v16, v18, vcc
    v_cvt_pk_bf16_f32 v16, v8, v9
    v_lshlrev_b32 v8, 16, v16
    v_and_b32 v9, 0xffff0000, v16
    v_cvt_pk_bf16_f32 v16, v10, v11
    v_lshlrev_b32 v10, 16, v16
    v_and_b32 v11, 0xffff0000, v16
    v_mul_f32 v8, v8, v12
    v_mul_f32 v9, v9, v13
    v_mul_f32 v10, v10, v14
    v_mul_f32 v11, v11, v15
    v_cvt_pk_bf16_f32 v8, v8, v9
    v_cvt_pk_bf16_f32 v10, v10, v11
    v_lshrrev_b32 v2, 5, v0
    v_lshlrev_b32 v2, 8, v2
    v_bfe_u32 v3, v0, 3, 2
    v_lshlrev_b32 v3, 6, v3
    v_and_b32 v4, 7, v0
    v_lshlrev_b32 v4, 1, v4
    v_add3_u32 v5, v2, v3, v4
    ds_write_b16 v5, v8 offset:7424
    ds_write_b16_d16_hi v5, v8 offset:7440
    ds_write_b16 v5, v10 offset:7456
    ds_write_b16_d16_hi v5, v10 offset:7472
    s_waitcnt lgkmcnt(0)
    v_mov_b32 v6, 6740
    v_mov_b32 v7, 1
    s_mov_b64 exec, 1
    ds_write_b32 v6, v7
    s_mov_b64 exec, -1
L_A3_OG:
    s_mov_b32 s55, s63
    s_lshr_b32 s44, s88, 3
    s_lshl_b32 s44, s44, 15
    s_bfe_u32 s45, s88, 0x10002
    s_lshl_b32 s45, s45, 8
    s_add_u32 s44, s44, s45
    s_add_u32 s44, s44, 1572864
    v_bfe_u32 v2, v0, 4, 1
    v_lshlrev_b32 v2, 14, v2
    v_lshrrev_b32 v3, 5, v0
    v_lshl_add_u32 v2, v3, 13, v2
    v_and_b32 v1, 15, v0
    v_lshl_add_u32 v1, v1, 4, v2
    s_lshr_b32 s48, s88, 6
    s_lshl_b32 s48, s48, 12
    s_bfe_u32 s49, s88, 0x30003
    s_lshl_b32 s49, s49, 2
    s_add_u32 s48, s48, s49
    s_add_u32 s48, s48, 2621440
    v_lshlrev_b32 v2, 6, v0
    v_mov_b32 v6, 6732
    s_mov_b32 s51, 4000000
LW_15:
    ds_read_b32 v7, v6
    s_waitcnt lgkmcnt(0)
    v_readfirstlane_b32 s50, v7
    s_cmp_ge_u32 s50, 4
    s_cbranch_scc1 LWD_16
    s_sleep 1
    s_sub_u32 s51, s51, 1
    s_cmp_lg_u32 s51, 0
    s_cbranch_scc1 LW_15
LWD_16:
    s_lshr_b32 s49, s88, 6
    s_add_u32 s49, s49, 8
    s_lshl_b32 s53, s49, 7
    s_add_u32 s53, s53, 2883584
    v_mov_b32 v6, 0
    s_mov_b32 s51, 40000
    s_mov_b64 exec, 1
FW_17:
    buffer_load_dword v7, v6, s[36:39], s53 offen sc1
    s_waitcnt vmcnt(0)
    v_readfirstlane_b32 s50, v7
    s_cmp_eq_u32 s50, s55
    s_cbranch_scc1 FWD_18
    s_sleep 2
    s_sub_u32 s51, s51, 1
    s_cmp_lg_u32 s51, 0
    s_cbranch_scc1 FW_17
FWD_18:
    s_mov_b64 exec, -1
    s_mov_b32 s51, 40000
PL_19:
    buffer_load_dword v8, v2, s[36:39], s48 offen sc1
    buffer_load_dword v9, v2, s[36:39], s48 offen offset:32 sc1
    s_add_u32 s46, s44, 0
    buffer_load_dwordx4 v[40:43], v1, s[36:39], s46 offen offset:0 sc1
    buffer_load_dwordx4 v[44:47], v1, s[36:39], s46 offen offset:512 sc1
    buffer_load_dwordx4 v[48:51], v1, s[36:39], s46 offen offset:1024 sc1
    buffer_load_dwordx4 v[52:55], v1, s[36:39], s46 offen offset:1536 sc1
    buffer_load_dwordx4 v[56:59], v1, s[36:39], s46 offen offset:2048 sc1
    buffer_load_dwordx4 v[60:63], v1, s[36:39], s46 offen offset:2560 sc1
    buffer_load_dwordx4 v[64:67], v1, s[36:39], s46 offen offset:3072 sc1
    buffer_load_dwordx4 v[68:71], v1, s[36:39], s46 offen offset:3584 sc1
    s_add_u32 s46, s44, 4096
    buffer_load_dwordx4 v[72:75], v1, s[36:39], s46 offen offset:0 sc1
    buffer_load_dwordx4 v[76:79], v1, s[36:39], s46 offen offset:512 sc1
    buffer_load_dwordx4 v[80:83], v1, s[36:39], s46 offen offset:1024 sc1
    buffer_load_dwordx4 v[84:87], v1, s[36:39], s46 offen offset:1536 sc1
    buffer_load_dwordx4 v[88:91], v1, s[36:39], s46 offen offset:2048 sc1
    buffer_load_dwordx4 v[92:95], v1, s[36:39], s46 offen offset:2560 sc1
    buffer_load_dwordx4 v[96:99], v1, s[36:39], s46 offen offset:3072 sc1
    buffer_load_dwordx4 v[100:103], v1, s[36:39], s46 offen offset:3584 sc1
    s_waitcnt vmcnt(0)
    v_max_u32 v7, v8, v9
    v_max3_u32 v7, v7, v40, v41
    v_max3_u32 v7, v7, v42, v43
    v_max3_u32 v7, v7, v44, v45
    v_max3_u32 v7, v7, v46, v47
    v_max3_u32 v7, v7, v48, v49
    v_max3_u32 v7, v7, v50, v51
    v_max3_u32 v7, v7, v52, v53
    v_max3_u32 v7, v7, v54, v55
    v_max3_u32 v7, v7, v56, v57
    v_max3_u32 v7, v7, v58, v59
    v_max3_u32 v7, v7, v60, v61
    v_max3_u32 v7, v7, v62, v63
    v_max3_u32 v7, v7, v64, v65
    v_max3_u32 v7, v7, v66, v67
    v_max3_u32 v7, v7, v68, v69
    v_max3_u32 v7, v7, v70, v71
    v_max3_u32 v7, v7, v72, v73
    v_max3_u32 v7, v7, v74, v75
    v_max3_u32 v7, v7, v76, v77
    v_max3_u32 v7, v7, v78, v79
    v_max3_u32 v7, v7, v80, v81
    v_max3_u32 v7, v7, v82, v83
    v_max3_u32 v7, v7, v84, v85
    v_max3_u32 v7, v7, v86, v87
    v_max3_u32 v7, v7, v88, v89
    v_max3_u32 v7, v7, v90, v91
    v_max3_u32 v7, v7, v92, v93
    v_max3_u32 v7, v7, v94, v95
    v_max3_u32 v7, v7, v96, v97
    v_max3_u32 v7, v7, v98, v99
    v_max3_u32 v7, v7, v100, v101
    v_max3_u32 v7, v7, v102, v103
    v_cmp_eq_u32 vcc, -1, v7
    s_cbranch_vccz PLD_20
    s_sleep 4
    s_sub_u32 s51, s51, 1
    s_cmp_lg_u32 s51, 0
    s_cbranch_scc1 PL_19
PLD_20:
    v_mov_b32 v10, v8
    s_nop 1
    v_max_f32_dpp v11, v10, v10 row_ror:1 row_mask:0xf bank_mask:0xf
    v_mov_b32 v10, v11
    s_nop 1
    v_max_f32_dpp v11, v10, v10 row_ror:2 row_mask:0xf bank_mask:0xf
    v_mov_b32 v10, v11
    s_nop 1
    v_max_f32_dpp v11, v10, v10 row_ror:4 row_mask:0xf bank_mask:0xf
    v_mov_b32 v10, v11
    s_nop 1
    v_max_f32_dpp v11, v10, v10 row_ror:8 row_mask:0xf bank_mask:0xf
    v_mov_b32 v10, v11
    v_mov_b32 v11, v10
    s_nop 1
    v_permlane16_swap_b32 v10, v11
    s_nop 1
    v_max_f32 v10, v10, v11
    v_sub_f32 v8, v8, v10
    v_mul_f32 v8, s60, v8
    v_exp_f32 v8, v8
    s_nop 0
    v_mul_f32 v9, v9, v8
    s_nop 1
    v_add_f32_dpp v11, v9, v9 row_ror:1 row_mask:0xf bank_mask:0xf
    v_mov_b32 v9, v11
    s_nop 1
    v_add_f32_dpp v11, v9, v9 row_ror:2 row_mask:0xf bank_mask:0xf
    v_mov_b32 v9, v11
    s_nop 1
    v_add_f32_dpp v11, v9, v9 row_ror:4 row_mask:0xf bank_mask:0xf
    v_mov_b32 v9, v11
    s_nop 1
    v_add_f32_dpp v11, v9, v9 row_ror:8 row_mask:0xf bank_mask:0xf
    v_mov_b32 v9, v11
    v_mov_b32 v11, v9
    s_nop 1
    v_permlane16_swap_b32 v9, v11
    s_nop 1
    v_add_f32 v9, v9, v11
    v_rcp_f32 v11, v9
    s_nop 0
    v_mul_f32 v12, v8, v11
    v_fma_f32 v10, -v12, v9, v8
    v_fma_f32 v10, v10, v11, v12
    v_lshlrev_b32 v2, 2, v0
    ds_write_b32 v2, v10 offset:7936
    v_bfe_u32 v2, v0, 4, 1
    v_lshlrev_b32 v2, 7, v2
    v_lshrrev_b32 v3, 5, v0
    v_lshl_add_u32 v2, v3, 6, v2
    s_waitcnt lgkmcnt(0)
    ds_read_b128 v[24:27], v2 offset:7936
    ds_read_b128 v[28:31], v2 offset:7952
    ds_read_b128 v[32:35], v2 offset:7968
    ds_read_b128 v[36:39], v2 offset:7984
    s_waitcnt lgkmcnt(0)
    v_mul_f32 v8, v40, v24
    v_mul_f32 v12, v44, v25
    v_fma_f32 v8, v48, v26, v8
    v_fma_f32 v12, v52, v27, v12
    v_fma_f32 v8, v56, v28, v8
    v_fma_f32 v12, v60, v29, v12
    v_fma_f32 v8, v64, v30, v8
    v_fma_f32 v12, v68, v31, v12
    v_fma_f32 v8, v72, v32, v8
    v_fma_f32 v12, v76, v33, v12
    v_fma_f32 v8, v80, v34, v8
    v_fma_f32 v12, v84, v35, v12
    v_fma_f32 v8, v88, v36, v8
    v_fma_f32 v12, v92, v37, v12
    v_fma_f32 v8, v96, v38, v8
    v_fma_f32 v12, v100, v39, v12
    v_add_f32 v8, v8, v12
    v_mul_f32 v9, v41, v24
    v_mul_f32 v13, v45, v25
    v_fma_f32 v9, v49, v26, v9
    v_fma_f32 v13, v53, v27, v13
    v_fma_f32 v9, v57, v28, v9
    v_fma_f32 v13, v61, v29, v13
    v_fma_f32 v9, v65, v30, v9
    v_fma_f32 v13, v69, v31, v13
    v_fma_f32 v9, v73, v32, v9
    v_fma_f32 v13, v77, v33, v13
    v_fma_f32 v9, v81, v34, v9
    v_fma_f32 v13, v85, v35, v13
    v_fma_f32 v9, v89, v36, v9
    v_fma_f32 v13, v93, v37, v13
    v_fma_f32 v9, v97, v38, v9
    v_fma_f32 v13, v101, v39, v13
    v_add_f32 v9, v9, v13
    v_mul_f32 v10, v42, v24
    v_mul_f32 v14, v46, v25
    v_fma_f32 v10, v50, v26, v10
    v_fma_f32 v14, v54, v27, v14
    v_fma_f32 v10, v58, v28, v10
    v_fma_f32 v14, v62, v29, v14
    v_fma_f32 v10, v66, v30, v10
    v_fma_f32 v14, v70, v31, v14
    v_fma_f32 v10, v74, v32, v10
    v_fma_f32 v14, v78, v33, v14
    v_fma_f32 v10, v82, v34, v10
    v_fma_f32 v14, v86, v35, v14
    v_fma_f32 v10, v90, v36, v10
    v_fma_f32 v14, v94, v37, v14
    v_fma_f32 v10, v98, v38, v10
    v_fma_f32 v14, v102, v39, v14
    v_add_f32 v10, v10, v14
    v_mul_f32 v11, v43, v24
    v_mul_f32 v15, v47, v25
    v_fma_f32 v11, v51, v26, v11
    v_fma_f32 v15, v55, v27, v15
    v_fma_f32 v11, v59, v28, v11
    v_fma_f32 v15, v63, v29, v15
    v_fma_f32 v11, v67, v30, v11
    v_fma_f32 v15, v71, v31, v15
    v_fma_f32 v11, v75, v32, v11
    v_fma_f32 v15, v79, v33, v15
    v_fma_f32 v11, v83, v34, v11
    v_fma_f32 v15, v87, v35, v15
    v_fma_f32 v11, v91, v36, v11
    v_fma_f32 v15, v95, v37, v15
    v_fma_f32 v11, v99, v38, v11
    v_fma_f32 v15, v103, v39, v15
    v_add_f32 v11, v11, v15
    v_mov_b32 v12, v8
    s_nop 1
    v_permlane32_swap_b32 v8, v12
    s_nop 1
    v_add_f32 v8, v8, v12
    v_mov_b32 v12, v9
    s_nop 1
    v_permlane32_swap_b32 v9, v12
    s_nop 1
    v_add_f32 v9, v9, v12
    v_mov_b32 v12, v10
    s_nop 1
    v_permlane32_swap_b32 v10, v12
    s_nop 1
    v_add_f32 v10, v10, v12
    v_mov_b32 v12, v11
    s_nop 1
    v_permlane32_swap_b32 v11, v12
    s_nop 1
    v_add_f32 v11, v11, v12
    v_cvt_pk_bf16_f32 v8, v8, v9
    v_cvt_pk_bf16_f32 v10, v10, v11
    v_bfe_u32 v2, v0, 4, 1
    v_lshlrev_b32 v2, 7, v2
    v_bfe_u32 v3, v0, 3, 1
    v_lshlrev_b32 v3, 6, v3
    v_and_b32 v4, 7, v0
    v_lshlrev_b32 v4, 1, v4
    v_add3_u32 v5, v2, v3, v4
    s_mov_b32 exec_hi, 0
    ds_write_b16 v5, v8 offset:6912
    ds_write_b16_d16_hi v5, v8 offset:6928
    ds_write_b16 v5, v10 offset:6944
    ds_write_b16_d16_hi v5, v10 offset:6960
    s_mov_b64 exec, -1
    s_waitcnt lgkmcnt(0)
    v_mov_b32 v6, 6736
    v_mov_b32 v7, 1
    s_mov_b64 exec, 1
    ds_write_b32 v6, v7
    s_mov_b64 exec, -1
    s_endpgm
L_A0:
    s_mov_b32 s40, s24
    s_mov_b32 s41, s25
    s_mov_b32 s42, 256
    s_mov_b32 s43, 0x20000
    s_memrealtime s[54:55]
    v_mov_b32 v8, -1
    v_mov_b32 v9, -1
    v_mov_b32 v10, -1
    v_mov_b32 v11, -1
    v_lshlrev_b32 v3, 4, v0
    v_lshrrev_b32 v4, 5, v0
    v_and_b32 v5, 31, v0
    v_lshlrev_b32 v5, 4, v5
    v_mov_b32 v13, 0
    v_mov_b32 v14, 0
    s_waitcnt lgkmcnt(0)
    s_or_b32 s54, s54, 1
    v_mov_b32 v12, s54
    s_lshr_b32 s46, s87, 6
    s_lshl_b32 s46, s46, 6
    s_mul_i32 s46, s46, 1
    s_mov_b64 exec, 1
    buffer_atomic_cmpswap v[12:13], v14, s[40:43], s46 offen sc0
    s_mov_b64 exec, -1
    s_sub_u32 s48, s89, 32
    s_and_b32 s48, s48, 255
    s_and_b32 s46, s48, 7
    s_lshl_b32 s46, s46, 15
    s_lshr_b32 s48, s48, 3
    s_lshl_b32 s48, s48, 9
    s_add_u32 s46, s46, s48
    s_add_u32 s56, s46, 1310720
    s_mov_b32 s46, s56
    v_lshl_add_u32 v6, v4, 14, v5
    buffer_store_dwordx4 v[8:11], v6, s[36:39], s46 offen offset:0 sc1
    s_and_b32 s46, s88, 3
    s_lshl_b32 s46, s46, 17
    s_lshr_b32 s48, s88, 2
    s_lshl_b32 s48, s48, 9
    s_add_u32 s46, s46, s48
    s_add_u32 s46, s46, 786432
    v_lshl_add_u32 v6, v4, 15, v5
    buffer_store_dwordx4 v[8:11], v6, s[36:39], s46 offen offset:0 sc1
    s_add_u32 s46, s46, 65536
    buffer_store_dwordx4 v[8:11], v6, s[36:39], s46 offen offset:0 sc1
    s_lshr_b32 s46, s86, 6
    s_lshl_b32 s46, s46, 18
    s_bfe_u32 s48, s86, 0x10005
    s_lshl_b32 s48, s48, 14
    s_add_u32 s46, s46, s48
    s_and_b32 s48, s86, 31
    s_lshl_b32 s48, s48, 9
    s_add_u32 s46, s46, s48
    s_add_u32 s46, s46, 1572864
    v_lshl_add_u32 v6, v4, 15, v5
    buffer_store_dwordx4 v[8:11], v6, s[36:39], s46 offen offset:0 sc1
    s_add_u32 s46, s46, 65536
    buffer_store_dwordx4 v[8:11], v6, s[36:39], s46 offen offset:0 sc1
    s_add_u32 s46, s46, 65536
    buffer_store_dwordx4 v[8:11], v6, s[36:39], s46 offen offset:0 sc1
    s_add_u32 s46, s46, 65536
    buffer_store_dwordx4 v[8:11], v6, s[36:39], s46 offen offset:0 sc1
    s_lshl_b32 s46, s86, 6
    s_add_u32 s46, s46, 2621440
    s_mov_b64 exec, 15
    buffer_store_dwordx4 v[8:11], v3, s[36:39], s46 offen offset:0 sc1
    s_mov_b64 exec, 1
    s_lshl_b32 s46, s2, 7
    s_add_u32 s46, s46, 3014656
    buffer_store_dword v14, v14, s[36:39], s46 offen sc1
    s_lshl_b32 s46, s86, 7
    s_add_u32 s46, s46, 3047424
    buffer_store_dword v14, v14, s[36:39], s46 offen sc1
    s_mov_b64 exec, -1
    s_lshr_b32 s47, s87, 6
    s_lshl_b32 s47, s47, 16
    s_and_b32 s48, s87, 63
    s_lshl_b32 s48, s48, 9
    s_add_u32 s47, s47, s48
    s_add_u32 s47, s47, 0
    s_mov_b32 s28, s10
    s_mov_b32 s29, s11
    s_mov_b32 s30, 8388608
    s_mov_b32 s31, 0x20000
    s_and_b32 s44, s87, 7
    s_lshl_b32 s45, s44, 20
    s_lshr_b32 s46, s87, 3
    s_lshl_b32 s46, s46, 8
    s_add_u32 s45, s45, s46
    v_lshrrev_b32 v4, 4, v0
    v_and_b32 v5, 15, v0
    v_lshlrev_b32 v1, 16, v4
    v_lshl_add_u32 v1, v5, 4, v1
    s_add_u32 s46, s45, 0
    buffer_load_dwordx4 v[40:43], v1, s[28:31], s46 offen nt
    s_add_u32 s46, s45, 8192
    buffer_load_dwordx4 v[44:47], v1, s[28:31], s46 offen nt
    s_add_u32 s46, s45, 16384
    buffer_load_dwordx4 v[48:51], v1, s[28:31], s46 offen nt
    s_add_u32 s46, s45, 24576
    buffer_load_dwordx4 v[52:55], v1, s[28:31], s46 offen nt
    s_add_u32 s46, s45, 32768
    buffer_load_dwordx4 v[56:59], v1, s[28:31], s46 offen nt
    s_add_u32 s46, s45, 40960
    buffer_load_dwordx4 v[60:63], v1, s[28:31], s46 offen nt
    s_add_u32 s46, s45, 49152
    buffer_load_dwordx4 v[64:67], v1, s[28:31], s46 offen nt
    s_add_u32 s46, s45, 57344
    buffer_load_dwordx4 v[68:71], v1, s[28:31], s46 offen nt
    s_add_u32 s46, s45, 262144
    buffer_load_dwordx4 v[72:75], v1, s[28:31], s46 offen nt
    s_add_u32 s46, s45, 270336
    buffer_load_dwordx4 v[76:79], v1, s[28:31], s46 offen nt
    s_add_u32 s46, s45, 278528
    buffer_load_dwordx4 v[80:83], v1, s[28:31], s46 offen nt
    s_add_u32 s46, s45, 286720
    buffer_load_dwordx4 v[84:87], v1, s[28:31], s46 offen nt
    s_add_u32 s46, s45, 294912
    buffer_load_dwordx4 v[88:91], v1, s[28:31], s46 offen nt
    s_add_u32 s46, s45, 303104
    buffer_load_dwordx4 v[92:95], v1, s[28:31], s46 offen nt
    s_add_u32 s46, s45, 311296
    buffer_load_dwordx4 v[96:99], v1, s[28:31], s46 offen nt
    s_add_u32 s46, s45, 319488
    buffer_load_dwordx4 v[100:103], v1, s[28:31], s46 offen nt
    s_add_u32 s46, s45, 524288
    buffer_load_dwordx4 v[104:107], v1, s[28:31], s46 offen nt
    s_add_u32 s46, s45, 532480
    buffer_load_dwordx4 v[108:111], v1, s[28:31], s46 offen nt
    s_add_u32 s46, s45, 540672
    buffer_load_dwordx4 v[112:115], v1, s[28:31], s46 offen nt
    s_add_u32 s46, s45, 548864
    buffer_load_dwordx4 v[116:119], v1, s[28:31], s46 offen nt
    s_add_u32 s46, s45, 557056
    buffer_load_dwordx4 v[120:123], v1, s[28:31], s46 offen nt
    s_add_u32 s46, s45, 565248
    buffer_load_dwordx4 v[124:127], v1, s[28:31], s46 offen nt
    s_add_u32 s46, s45, 573440
    buffer_load_dwordx4 v[128:131], v1, s[28:31], s46 offen nt
    s_add_u32 s46, s45, 581632
    buffer_load_dwordx4 v[132:135], v1, s[28:31], s46 offen nt
    s_add_u32 s46, s45, 786432
    buffer_load_dwordx4 v[136:139], v1, s[28:31], s46 offen nt
    s_add_u32 s46, s45, 794624
    buffer_load_dwordx4 v[140:143], v1, s[28:31], s46 offen nt
    s_add_u32 s46, s45, 802816
    buffer_load_dwordx4 v[144:147], v1, s[28:31], s46 offen nt
    s_add_u32 s46, s45, 811008
    buffer_load_dwordx4 v[148:151], v1, s[28:31], s46 offen nt
    s_add_u32 s46, s45, 819200
    buffer_load_dwordx4 v[152:155], v1, s[28:31], s46 offen nt
    s_add_u32 s46, s45, 827392
    buffer_load_dwordx4 v[156:159], v1, s[28:31], s46 offen nt
    s_add_u32 s46, s45, 835584
    buffer_load_dwordx4 v[160:163], v1, s[28:31], s46 offen nt
    s_add_u32 s46, s45, 843776
    buffer_load_dwordx4 v[164:167], v1, s[28:31], s46 offen nt
    v_and_b32 v2, 1, v0
    v_lshlrev_b32 v3, 11, v2
    v_lshl_add_u32 v3, v4, 4, v3
    s_lshl_b32 s46, s44, 8
    v_add_u32 v3, s46, v3
    v_lshlrev_b32 v2, 15, v2
    v_lshl_add_u32 v2, v4, 7, v2
    v_bfe_u32 v6, v0, 1, 3
    v_lshl_add_u32 v2, v6, 4, v2
    s_barrier
    v_mov_b32 v6, 6752
    s_mov_b32 s51, 4000000
LW_21:
    ds_read_b32 v7, v6
    s_waitcnt lgkmcnt(0)
    v_readfirstlane_b32 s50, v7
    s_cmp_ge_u32 s50, 1
    s_cbranch_scc1 LWD_22
    s_sleep 1
    s_sub_u32 s51, s51, 1
    s_cmp_lg_u32 s51, 0
    s_cbranch_scc1 LW_21
LWD_22:
    s_waitcnt vmcnt(32)
    v_readfirstlane_b32 s55, v12
    s_cmp_eq_u32 s55, 0
    s_cselect_b32 s55, s54, s55
    v_mov_b32 v6, 6744
    v_mov_b32 v7, s55
    s_mov_b64 exec, 1
    ds_write_b32 v6, v7
    s_mov_b64 exec, -1
    ds_read_b128 v[8:11], v3 offset:0
    s_waitcnt vmcnt(24)
    v_perm_b32 v16, v44, v40, s58
    v_perm_b32 v17, v52, v48, s58
    v_perm_b32 v18, v60, v56, s58
    v_perm_b32 v19, v68, v64, s58
    s_waitcnt lgkmcnt(0)
    s_nop 0
    v_mfma_f32_16x16x32_bf16 v[24:27], v[16:19], v[8:11], 0
    v_perm_b32 v20, v44, v40, s59
    v_perm_b32 v21, v52, v48, s59
    v_perm_b32 v22, v60, v56, s59
    v_perm_b32 v23, v68, v64, s59
    s_nop 1
    v_mfma_f32_16x16x32_bf16 v[28:31], v[20:23], v[8:11], 0
    v_perm_b32 v16, v45, v41, s58
    v_perm_b32 v17, v53, v49, s58
    v_perm_b32 v18, v61, v57, s58
    v_perm_b32 v19, v69, v65, s58
    s_nop 1
    v_mfma_f32_16x16x32_bf16 v[32:35], v[16:19], v[8:11], 0
    v_perm_b32 v20, v45, v41, s59
    v_perm_b32 v21, v53, v49, s59
    v_perm_b32 v22, v61, v57, s59
    v_perm_b32 v23, v69, v65, s59
    s_nop 1
    v_mfma_f32_16x16x32_bf16 v[36:39], v[20:23], v[8:11], 0
    ds_read_b128 v[12:15], v3 offset:64
    s_waitcnt vmcnt(16)
    v_perm_b32 v16, v76, v72, s58
    v_perm_b32 v17, v84, v80, s58
    v_perm_b32 v18, v92, v88, s58
    v_perm_b32 v19, v100, v96, s58
    s_waitcnt lgkmcnt(0)
    s_nop 0
    v_mfma_f32_16x16x32_bf16 v[24:27], v[16:19], v[12:15], v[24:27]
    v_perm_b32 v20, v76, v72, s59
    v_perm_b32 v21, v84, v80, s59
    v_perm_b32 v22, v92, v88, s59
    v_perm_b32 v23, v100, v96, s59
    s_nop 1
    v_mfma_f32_16x16x32_bf16 v[28:31], v[20:23], v[12:15], v[28:31]
    v_perm_b32 v16, v77, v73, s58
    v_perm_b32 v17, v85, v81, s58
    v_perm_b32 v18, v93, v89, s58
    v_perm_b32 v19, v101, v97, s58
    s_nop 1
    v_mfma_f32_16x16x32_bf16 v[32:35], v[16:19], v[12:15], v[32:35]
    v_perm_b32 v20, v77, v73, s59
    v_perm_b32 v21, v85, v81, s59
    v_perm_b32 v22, v93, v89, s59
    v_perm_b32 v23, v101, v97, s59
    s_nop 1
    v_mfma_f32_16x16x32_bf16 v[36:39], v[20:23], v[12:15], v[36:39]
    ds_read_b128 v[8:11], v3 offset:128
    s_waitcnt vmcnt(8)
    v_perm_b32 v16, v108, v104, s58
    v_perm_b32 v17, v116, v112, s58
    v_perm_b32 v18, v124, v120, s58
    v_perm_b32 v19, v132, v128, s58
    s_waitcnt lgkmcnt(0)
    s_nop 0
    v_mfma_f32_16x16x32_bf16 v[24:27], v[16:19], v[8:11], v[24:27]
    v_perm_b32 v20, v108, v104, s59
    v_perm_b32 v21, v116, v112, s59
    v_perm_b32 v22, v124, v120, s59
    v_perm_b32 v23, v132, v128, s59
    s_nop 1
    v_mfma_f32_16x16x32_bf16 v[28:31], v[20:23], v[8:11], v[28:31]
    v_perm_b32 v16, v109, v105, s58
    v_perm_b32 v17, v117, v113, s58
    v_perm_b32 v18, v125, v121, s58
    v_perm_b32 v19, v133, v129, s58
    s_nop 1
    v_mfma_f32_16x16x32_bf16 v[32:35], v[16:19], v[8:11], v[32:35]
    v_perm_b32 v20, v109, v105, s59
    v_perm_b32 v21, v117, v113, s59
    v_perm_b32 v22, v125, v121, s59
    v_perm_b32 v23, v133, v129, s59
    s_nop 1
    v_mfma_f32_16x16x32_bf16 v[36:39], v[20:23], v[8:11], v[36:39]
    ds_read_b128 v[12:15], v3 offset:192
    s_waitcnt vmcnt(0)
    v_perm_b32 v16, v140, v136, s58
    v_perm_b32 v17, v148, v144, s58
    v_perm_b32 v18, v156, v152, s58
    v_perm_b32 v19, v164, v160, s58
    s_waitcnt lgkmcnt(0)
    s_nop 0
    v_mfma_f32_16x16x32_bf16 v[24:27], v[16:19], v[12:15], v[24:27]
    v_perm_b32 v20, v140, v136, s59
    v_perm_b32 v21, v148, v144, s59
    v_perm_b32 v22, v156, v152, s59
    v_perm_b32 v23, v164, v160, s59
    s_nop 1
    v_mfma_f32_16x16x32_bf16 v[28:31], v[20:23], v[12:15], v[28:31]
    v_perm_b32 v16, v141, v137, s58
    v_perm_b32 v17, v149, v145, s58
    v_perm_b32 v18, v157, v153, s58
    v_perm_b32 v19, v165, v161, s58
    s_nop 1
    v_mfma_f32_16x16x32_bf16 v[32:35], v[16:19], v[12:15], v[32:35]
    v_perm_b32 v20, v141, v137, s59
    v_perm_b32 v21, v149, v145, s59
    v_perm_b32 v22, v157, v153, s59
    v_perm_b32 v23, v165, v161, s59
    s_nop 1
    v_mfma_f32_16x16x32_bf16 v[36:39], v[20:23], v[12:15], v[36:39]
    s_nop 7
    s_nop 1
    v_cndmask_b32 v24, v24, v28, s[80:81]
    v_cndmask_b32 v25, v25, v29, s[80:81]
    v_cndmask_b32 v26, v26, v30, s[80:81]
    v_cndmask_b32 v27, v27, v31, s[80:81]
    v_cndmask_b32 v32, v32, v36, s[80:81]
    v_cndmask_b32 v33, v33, v37, s[80:81]
    v_cndmask_b32 v34, v34, v38, s[80:81]
    v_cndmask_b32 v35, v35, v39, s[80:81]
    v_cndmask_b32 v24, v24, v32, s[82:83]
    v_cndmask_b32 v25, v25, v33, s[82:83]
    v_cndmask_b32 v26, v26, v34, s[82:83]
    v_cndmask_b32 v27, v27, v35, s[82:83]
    s_not_b64 exec, s[84:85]
    v_mov_b32 v16, v27
    v_mov_b32 v17, s55
    v_mov_b32 v27, s55
    v_lshrrev_b32 v7, 1, v2
    s_lshr_b32 s57, s47, 1
    s_add_u32 s57, s57, 3145728
    buffer_store_dwordx4 v[24:27], v2, s[36:39], s47 offen sc1
    buffer_store_dwordx2 v[16:17], v7, s[36:39], s57 offen sc1
    s_mov_b64 exec, -1
    s_nop 1
    ds_read_b128 v[8:11], v3 offset:0
    v_perm_b32 v16, v46, v42, s58
    v_perm_b32 v17, v54, v50, s58
    v_perm_b32 v18, v62, v58, s58
    v_perm_b32 v19, v70, v66, s58
    s_waitcnt lgkmcnt(0)
    s_nop 0
    v_mfma_f32_16x16x32_bf16 v[24:27], v[16:19], v[8:11], 0
    v_perm_b32 v20, v46, v42, s59
    v_perm_b32 v21, v54, v50, s59
    v_perm_b32 v22, v62, v58, s59
    v_perm_b32 v23, v70, v66, s59
    s_nop 1
    v_mfma_f32_16x16x32_bf16 v[28:31], v[20:23], v[8:11], 0
    v_perm_b32 v16, v47, v43, s58
    v_perm_b32 v17, v55, v51, s58
    v_perm_b32 v18, v63, v59, s58
    v_perm_b32 v19, v71, v67, s58
    s_nop 1
    v_mfma_f32_16x16x32_bf16 v[32:35], v[16:19], v[8:11], 0
    v_perm_b32 v20, v47, v43, s59
    v_perm_b32 v21, v55, v51, s59
    v_perm_b32 v22, v63, v59, s59
    v_perm_b32 v23, v71, v67, s59
    s_nop 1
    v_mfma_f32_16x16x32_bf16 v[36:39], v[20:23], v[8:11], 0
    ds_read_b128 v[12:15], v3 offset:64
    v_perm_b32 v16, v78, v74, s58
    v_perm_b32 v17, v86, v82, s58
    v_perm_b32 v18, v94, v90, s58
    v_perm_b32 v19, v102, v98, s58
    s_waitcnt lgkmcnt(0)
    s_nop 0
    v_mfma_f32_16x16x32_bf16 v[24:27], v[16:19], v[12:15], v[24:27]
    v_perm_b32 v20, v78, v74, s59
    v_perm_b32 v21, v86, v82, s59
    v_perm_b32 v22, v94, v90, s59
    v_perm_b32 v23, v102, v98, s59
    s_nop 1
    v_mfma_f32_16x16x32_bf16 v[28:31], v[20:23], v[12:15], v[28:31]
    v_perm_b32 v16, v79, v75, s58
    v_perm_b32 v17, v87, v83, s58
    v_perm_b32 v18, v95, v91, s58
    v_perm_b32 v19, v103, v99, s58
    s_nop 1
    v_mfma_f32_16x16x32_bf16 v[32:35], v[16:19], v[12:15], v[32:35]
    v_perm_b32 v20, v79, v75, s59
    v_perm_b32 v21, v87, v83, s59
    v_perm_b32 v22, v95, v91, s59
    v_perm_b32 v23, v103, v99, s59
    s_nop 1
    v_mfma_f32_16x16x32_bf16 v[36:39], v[20:23], v[12:15], v[36:39]
    ds_read_b128 v[8:11], v3 offset:128
    v_perm_b32 v16, v110, v106, s58
    v_perm_b32 v17, v118, v114, s58
    v_perm_b32 v18, v126, v122, s58
    v_perm_b32 v19, v134, v130, s58
    s_waitcnt lgkmcnt(0)
    s_nop 0
    v_mfma_f32_16x16x32_bf16 v[24:27], v[16:19], v[8:11], v[24:27]
    v_perm_b32 v20, v110, v106, s59
    v_perm_b32 v21, v118, v114, s59
    v_perm_b32 v22, v126, v122, s59
    v_perm_b32 v23, v134, v130, s59
    s_nop 1
    v_mfma_f32_16x16x32_bf16 v[28:31], v[20:23], v[8:11], v[28:31]
    v_perm_b32 v16, v111, v107, s58
    v_perm_b32 v17, v119, v115, s58
    v_perm_b32 v18, v127, v123, s58
    v_perm_b32 v19, v135, v131, s58
    s_nop 1
    v_mfma_f32_16x16x32_bf16 v[32:35], v[16:19], v[8:11], v[32:35]
    v_perm_b32 v20, v111, v107, s59
    v_perm_b32 v21, v119, v115, s59
    v_perm_b32 v22, v127, v123, s59
    v_perm_b32 v23, v135, v131, s59
    s_nop 1
    v_mfma_f32_16x16x32_bf16 v[36:39], v[20:23], v[8:11], v[36:39]
    ds_read_b128 v[12:15], v3 offset:192
    v_perm_b32 v16, v142, v138, s58
    v_perm_b32 v17, v150, v146, s58
    v_perm_b32 v18, v158, v154, s58
    v_perm_b32 v19, v166, v162, s58
    s_waitcnt lgkmcnt(0)
    s_nop 0
    v_mfma_f32_16x16x32_bf16 v[24:27], v[16:19], v[12:15], v[24:27]
    v_perm_b32 v20, v142, v138, s59
    v_perm_b32 v21, v150, v146, s59
    v_perm_b32 v22, v158, v154, s59
    v_perm_b32 v23, v166, v162, s59
    s_nop 1
    v_mfma_f32_16x16x32_bf16 v[28:31], v[20:23], v[12:15], v[28:31]
    v_perm_b32 v16, v143, v139, s58
    v_perm_b32 v17, v151, v147, s58
    v_perm_b32 v18, v159, v155, s58
    v_perm_b32 v19, v167, v163, s58
    s_nop 1
    v_mfma_f32_16x16x32_bf16 v[32:35], v[16:19], v[12:15], v[32:35]
    v_perm_b32 v20, v143, v139, s59
    v_perm_b32 v21, v151, v147, s59
    v_perm_b32 v22, v159, v155, s59
    v_perm_b32 v23, v167, v163, s59
    s_nop 1
    v_mfma_f32_16x16x32_bf16 v[36:39], v[20:23], v[12:15], v[36:39]
    s_nop 7
    s_nop 1
    v_cndmask_b32 v24, v24, v28, s[80:81]
    v_cndmask_b32 v25, v25, v29, s[80:81]
    v_cndmask_b32 v26, v26, v30, s[80:81]
    v_cndmask_b32 v27, v27, v31, s[80:81]
    v_cndmask_b32 v32, v32, v36, s[80:81]
    v_cndmask_b32 v33, v33, v37, s[80:81]
    v_cndmask_b32 v34, v34, v38, s[80:81]
    v_cndmask_b32 v35, v35, v39, s[80:81]
    v_cndmask_b32 v24, v24, v32, s[82:83]
    v_cndmask_b32 v25, v25, v33, s[82:83]
    v_cndmask_b32 v26, v26, v34, s[82:83]
    v_cndmask_b32 v27, v27, v35, s[82:83]
    s_mov_b64 exec, s[84:85]
    v_mov_b32 v16, v27
    v_mov_b32 v17, s55
    v_mov_b32 v27, s55
    v_lshrrev_b32 v7, 1, v2
    s_lshr_b32 s57, s47, 1
    s_add_u32 s57, s57, 3145728
    buffer_store_dwordx4 v[24:27], v2, s[36:39], s47 offen sc1
    buffer_store_dwordx2 v[16:17], v7, s[36:39], s57 offen sc1
    s_mov_b64 exec, -1
    s_nop 1
    s_mov_b32 s32, s20
    s_mov_b32 s33, s21
    s_mov_b32 s34, 7340032
    s_mov_b32 s35, 0x20000
    s_lshr_b32 s48, s87, 6
    s_add_u32 s48, s48, 1
    s_lshl_b32 s46, s48, 6
    s_add_u32 s46, s46, -32
    v_mov_b32 v6, s46
    v_mov_b32 v7, 1
    s_nop 0
    s_mov_b64 exec, 1
    buffer_atomic_add v7, v6, s[40:43], 0 offen sc0
    s_waitcnt vmcnt(0)
    v_readfirstlane_b32 s46, v7
    s_cmp_eq_u32 s46, 63
    s_cbranch_scc0 ARR_23
    s_lshl_b32 s46, s48, 7
    s_add_u32 s46, s46, 2883584
    v_mov_b32 v6, 0
    v_mov_b32 v7, s55
    buffer_store_dword v7, v6, s[36:39], s46 offen sc1
ARR_23:
    s_mov_b64 exec, -1
    s_waitcnt lgkmcnt(0)
    v_mov_b32 v6, 6764
    v_mov_b32 v7, 1
    s_mov_b64 exec, 1
    ds_write_b32 v6, v7
    s_mov_b64 exec, -1
    s_lshr_b32 s44, s86, 5
    s_lshl_b32 s44, s44, 15
    s_add_u32 s44, s44, 0
    s_lshr_b32 s45, s44, 1
    s_add_u32 s45, s45, 3145728
    s_lshr_b32 s48, s86, 6
    s_add_u32 s48, s48, 1
    s_lshl_b32 s46, s48, 7
    s_add_u32 s46, s46, 2883584
    v_mov_b32 v6, 0
    s_mov_b32 s51, 40000
    s_mov_b64 exec, 1
FW_24:
    buffer_load_dword v7, v6, s[36:39], s46 offen sc1
    s_waitcnt vmcnt(0)
    v_readfirstlane_b32 s50, v7
    s_cmp_eq_u32 s50, s55
    s_cbranch_scc1 FWD_25
    s_sleep 4
    s_sub_u32 s51, s51, 1
    s_cmp_lg_u32 s51, 0
    s_cbranch_scc1 FW_24
FWD_25:
    s_mov_b64 exec, -1
    v_lshrrev_b32 v2, 5, v0
    v_lshlrev_b32 v2, 12, v2
    v_and_b32 v3, 31, v0
    v_lshl_add_u32 v2, v3, 4, v2
    v_lshrrev_b32 v3, 1, v2
    v_lshrrev_b32 v8, 5, v0
    v_lshlrev_b32 v8, 8, v8
    v_bfe_u32 v9, v0, 3, 2
    v_lshlrev_b32 v9, 6, v9
    v_and_b32 v10, 7, v0
    v_lshlrev_b32 v10, 1, v10
    v_add3_u32 v8, v8, v9, v10
    s_add_u32 s46, s44, 0
    s_add_u32 s48, s45, 0
    buffer_load_dwordx4 v[40:43], v2, s[36:39], s46 offen offset:0
    buffer_load_dwordx2 v[104:105], v3, s[36:39], s48 offen offset:0
    buffer_load_dwordx4 v[44:47], v2, s[36:39], s46 offen offset:512
    buffer_load_dwordx2 v[106:107], v3, s[36:39], s48 offen offset:256
    buffer_load_dwordx4 v[48:51], v2, s[36:39], s46 offen offset:1024
    buffer_load_dwordx2 v[108:109], v3, s[36:39], s48 offen offset:512
    buffer_load_dwordx4 v[52:55], v2, s[36:39], s46 offen offset:1536
    buffer_load_dwordx2 v[110:111], v3, s[36:39], s48 offen offset:768
    buffer_load_dwordx4 v[56:59], v2, s[36:39], s46 offen offset:2048
    buffer_load_dwordx2 v[112:113], v3, s[36:39], s48 offen offset:1024
    buffer_load_dwordx4 v[60:63], v2, s[36:39], s46 offen offset:2560
    buffer_load_dwordx2 v[114:115], v3, s[36:39], s48 offen offset:1280
    buffer_load_dwordx4 v[64:67], v2, s[36:39], s46 offen offset:3072
    buffer_load_dwordx2 v[116:117], v3, s[36:39], s48 offen offset:1536
    buffer_load_dwordx4 v[68:71], v2, s[36:39], s46 offen offset:3584
    buffer_load_dwordx2 v[118:119], v3, s[36:39], s48 offen offset:1792
    s_add_u32 s46, s44, 8192
    s_add_u32 s48, s45, 4096
    buffer_load_dwordx4 v[72:75], v2, s[36:39], s46 offen offset:0
    buffer_load_dwordx2 v[120:121], v3, s[36:39], s48 offen offset:0
    buffer_load_dwordx4 v[76:79], v2, s[36:39], s46 offen offset:512
    buffer_load_dwordx2 v[122:123], v3, s[36:39], s48 offen offset:256
    buffer_load_dwordx4 v[80:83], v2, s[36:39], s46 offen offset:1024
    buffer_load_dwordx2 v[124:125], v3, s[36:39], s48 offen offset:512
    buffer_load_dwordx4 v[84:87], v2, s[36:39], s46 offen offset:1536
    buffer_load_dwordx2 v[126:127], v3, s[36:39], s48 offen offset:768
    buffer_load_dwordx4 v[88:91], v2, s[36:39], s46 offen offset:2048
    buffer_load_dwordx2 v[128:129], v3, s[36:39], s48 offen offset:1024
    buffer_load_dwordx4 v[92:95], v2, s[36:39], s46 offen offset:2560
    buffer_load_dwordx2 v[130:131], v3, s[36:39], s48 offen offset:1280
    buffer_load_dwordx4 v[96:99], v2, s[36:39], s46 offen offset:3072
    buffer_load_dwordx2 v[132:133], v3, s[36:39], s48 offen offset:1536
    buffer_load_dwordx4 v[100:103], v2, s[36:39], s46 offen offset:3584
    buffer_load_dwordx2 v[134:135], v3, s[36:39], s48 offen offset:1792
    s_waitcnt vmcnt(0)
    v_xor_b32 v7, s55, v43
    v_xor_b32 v6, s55, v47
    v_or_b32 v7, v7, v6
    v_xor_b32 v6, s55, v51
    v_or_b32 v7, v7, v6
    v_xor_b32 v6, s55, v55
    v_or_b32 v7, v7, v6
    v_xor_b32 v6, s55, v59
    v_or_b32 v7, v7, v6
    v_xor_b32 v6, s55, v63
    v_or_b32 v7, v7, v6
    v_xor_b32 v6, s55, v67
    v_or_b32 v7, v7, v6
    v_xor_b32 v6, s55, v71
    v_or_b32 v7, v7, v6
    v_xor_b32 v6, s55, v75
    v_or_b32 v7, v7, v6
    v_xor_b32 v6, s55, v79
    v_or_b32 v7, v7, v6
    v_xor_b32 v6, s55, v83
    v_or_b32 v7, v7, v6
    v_xor_b32 v6, s55, v87
    v_or_b32 v7, v7, v6
    v_xor_b32 v6, s55, v91
    v_or_b32 v7, v7, v6
    v_xor_b32 v6, s55, v95
    v_or_b32 v7, v7, v6
    v_xor_b32 v6, s55, v99
    v_or_b32 v7, v7, v6
    v_xor_b32 v6, s55, v103
    v_or_b32 v7, v7, v6
    v_xor_b32 v6, s55, v105
    v_or_b32 v7, v7, v6
    v_xor_b32 v6, s55, v107
    v_or_b32 v7, v7, v6
    v_xor_b32 v6, s55, v109
    v_or_b32 v7, v7, v6
    v_xor_b32 v6, s55, v111
    v_or_b32 v7, v7, v6
    v_xor_b32 v6, s55, v113
    v_or_b32 v7, v7, v6
    v_xor_b32 v6, s55, v115
    v_or_b32 v7, v7, v6
    v_xor_b32 v6, s55, v117
    v_or_b32 v7, v7, v6
    v_xor_b32 v6, s55, v119
    v_or_b32 v7, v7, v6
    v_xor_b32 v6, s55, v121
    v_or_b32 v7, v7, v6
    v_xor_b32 v6, s55, v123
    v_or_b32 v7, v7, v6
    v_xor_b32 v6, s55, v125
    v_or_b32 v7, v7, v6
    v_xor_b32 v6, s55, v127
    v_or_b32 v7, v7, v6
    v_xor_b32 v6, s55, v129
    v_or_b32 v7, v7, v6
    v_xor_b32 v6, s55, v131
    v_or_b32 v7, v7, v6
    v_xor_b32 v6, s55, v133
    v_or_b32 v7, v7, v6
    v_xor_b32 v6, s55, v135
    v_or_b32 v7, v7, v6
    v_cmp_ne_u32 vcc, 0, v7
    s_cbranch_vccz TPD_27
    s_mov_b32 s51, 40000
TP_26:
    s_add_u32 s46, s44, 0
    s_add_u32 s48, s45, 0
    buffer_load_dwordx4 v[40:43], v2, s[36:39], s46 offen offset:0 sc1
    buffer_load_dwordx2 v[104:105], v3, s[36:39], s48 offen offset:0 sc1
    buffer_load_dwordx4 v[44:47], v2, s[36:39], s46 offen offset:512 sc1
    buffer_load_dwordx2 v[106:107], v3, s[36:39], s48 offen offset:256 sc1
    buffer_load_dwordx4 v[48:51], v2, s[36:39], s46 offen offset:1024 sc1
    buffer_load_dwordx2 v[108:109], v3, s[36:39], s48 offen offset:512 sc1
    buffer_load_dwordx4 v[52:55], v2, s[36:39], s46 offen offset:1536 sc1
    buffer_load_dwordx2 v[110:111], v3, s[36:39], s48 offen offset:768 sc1
    buffer_load_dwordx4 v[56:59], v2, s[36:39], s46 offen offset:2048 sc1
    buffer_load_dwordx2 v[112:113], v3, s[36:39], s48 offen offset:1024 sc1
    buffer_load_dwordx4 v[60:63], v2, s[36:39], s46 offen offset:2560 sc1
    buffer_load_dwordx2 v[114:115], v3, s[36:39], s48 offen offset:1280 sc1
    buffer_load_dwordx4 v[64:67], v2, s[36:39], s46 offen offset:3072 sc1
    buffer_load_dwordx2 v[116:117], v3, s[36:39], s48 offen offset:1536 sc1
    buffer_load_dwordx4 v[68:71], v2, s[36:39], s46 offen offset:3584 sc1
    buffer_load_dwordx2 v[118:119], v3, s[36:39], s48 offen offset:1792 sc1
    s_add_u32 s46, s44, 8192
    s_add_u32 s48, s45, 4096
    buffer_load_dwordx4 v[72:75], v2, s[36:39], s46 offen offset:0 sc1
    buffer_load_dwordx2 v[120:121], v3, s[36:39], s48 offen offset:0 sc1
    buffer_load_dwordx4 v[76:79], v2, s[36:39], s46 offen offset:512 sc1
    buffer_load_dwordx2 v[122:123], v3, s[36:39], s48 offen offset:256 sc1
    buffer_load_dwordx4 v[80:83], v2, s[36:39], s46 offen offset:1024 sc1
    buffer_load_dwordx2 v[124:125], v3, s[36:39], s48 offen offset:512 sc1
    buffer_load_dwordx4 v[84:87], v2, s[36:39], s46 offen offset:1536 sc1
    buffer_load_dwordx2 v[126:127], v3, s[36:39], s48 offen offset:768 sc1
    buffer_load_dwordx4 v[88:91], v2, s[36:39], s46 offen offset:2048 sc1
    buffer_load_dwordx2 v[128:129], v3, s[36:39], s48 offen offset:1024 sc1
    buffer_load_dwordx4 v[92:95], v2, s[36:39], s46 offen offset:2560 sc1
    buffer_load_dwordx2 v[130:131], v3, s[36:39], s48 offen offset:1280 sc1
    buffer_load_dwordx4 v[96:99], v2, s[36:39], s46 offen offset:3072 sc1
    buffer_load_dwordx2 v[132:133], v3, s[36:39], s48 offen offset:1536 sc1
    buffer_load_dwordx4 v[100:103], v2, s[36:39], s46 offen offset:3584 sc1
    buffer_load_dwordx2 v[134:135], v3, s[36:39], s48 offen offset:1792 sc1
    s_waitcnt vmcnt(0)
    v_xor_b32 v7, s55, v43
    v_xor_b32 v6, s55, v47
    v_or_b32 v7, v7, v6
    v_xor_b32 v6, s55, v51
    v_or_b32 v7, v7, v6
    v_xor_b32 v6, s55, v55
    v_or_b32 v7, v7, v6
    v_xor_b32 v6, s55, v59
    v_or_b32 v7, v7, v6
    v_xor_b32 v6, s55, v63
    v_or_b32 v7, v7, v6
    v_xor_b32 v6, s55, v67
    v_or_b32 v7, v7, v6
    v_xor_b32 v6, s55, v71
    v_or_b32 v7, v7, v6
    v_xor_b32 v6, s55, v75
    v_or_b32 v7, v7, v6
    v_xor_b32 v6, s55, v79
    v_or_b32 v7, v7, v6
    v_xor_b32 v6, s55, v83
    v_or_b32 v7, v7, v6
    v_xor_b32 v6, s55, v87
    v_or_b32 v7, v7, v6
    v_xor_b32 v6, s55, v91
    v_or_b32 v7, v7, v6
    v_xor_b32 v6, s55, v95
    v_or_b32 v7, v7, v6
    v_xor_b32 v6, s55, v99
    v_or_b32 v7, v7, v6
    v_xor_b32 v6, s55, v103
    v_or_b32 v7, v7, v6
    v_xor_b32 v6, s55, v105
    v_or_b32 v7, v7, v6
    v_xor_b32 v6, s55, v107
    v_or_b32 v7, v7, v6
    v_xor_b32 v6, s55, v109
    v_or_b32 v7, v7, v6
    v_xor_b32 v6, s55, v111
    v_or_b32 v7, v7, v6
    v_xor_b32 v6, s55, v113
    v_or_b32 v7, v7, v6
    v_xor_b32 v6, s55, v115
    v_or_b32 v7, v7, v6
    v_xor_b32 v6, s55, v117
    v_or_b32 v7, v7, v6
    v_xor_b32 v6, s55, v119
    v_or_b32 v7, v7, v6
    v_xor_b32 v6, s55, v121
    v_or_b32 v7, v7, v6
    v_xor_b32 v6, s55, v123
    v_or_b32 v7, v7, v6
    v_xor_b32 v6, s55, v125
    v_or_b32 v7, v7, v6
    v_xor_b32 v6, s55, v127
    v_or_b32 v7, v7, v6
    v_xor_b32 v6, s55, v129
    v_or_b32 v7, v7, v6
    v_xor_b32 v6, s55, v131
    v_or_b32 v7, v7, v6
    v_xor_b32 v6, s55, v133
    v_or_b32 v7, v7, v6
    v_xor_b32 v6, s55, v135
    v_or_b32 v7, v7, v6
    v_cmp_ne_u32 vcc, 0, v7
    s_cbranch_vccz TPD_27
    s_sleep 4
    s_sub_u32 s51, s51, 1
    s_cmp_lg_u32 s51, 0
    s_cbranch_scc1 TP_26
TPD_27:
    v_add_f32 v12, v40, v44
    v_add_f32 v12, v12, v48
    v_add_f32 v12, v12, v52
    v_add_f32 v12, v12, v56
    v_add_f32 v12, v12, v60
    v_add_f32 v12, v12, v64
    v_add_f32 v12, v12, v68
    v_add_f32 v13, v41, v45
    v_add_f32 v13, v13, v49
    v_add_f32 v13, v13, v53
    v_add_f32 v13, v13, v57
    v_add_f32 v13, v13, v61
    v_add_f32 v13, v13, v65
    v_add_f32 v13, v13, v69
    v_add_f32 v14, v42, v46
    v_add_f32 v14, v14, v50
    v_add_f32 v14, v14, v54
    v_add_f32 v14, v14, v58
    v_add_f32 v14, v14, v62
    v_add_f32 v14, v14, v66
    v_add_f32 v14, v14, v70
    v_add_f32 v15, v104, v106
    v_add_f32 v15, v15, v108
    v_add_f32 v15, v15, v110
    v_add_f32 v15, v15, v112
    v_add_f32 v15, v15, v114
    v_add_f32 v15, v15, v116
    v_add_f32 v15, v15, v118
    v_cvt_pk_bf16_f32 v12, v12, v13
    v_cvt_pk_bf16_f32 v14, v14, v15
    ds_write_b16 v8, v12 offset:4096
    ds_write_b16_d16_hi v8, v12 offset:4112
    ds_write_b16 v8, v14 offset:4128
    ds_write_b16_d16_hi v8, v14 offset:4144
    v_add_f32 v12, v72, v76
    v_add_f32 v12, v12, v80
    v_add_f32 v12, v12, v84
    v_add_f32 v12, v12, v88
    v_add_f32 v12, v12, v92
    v_add_f32 v12, v12, v96
    v_add_f32 v12, v12, v100
    v_add_f32 v13, v73, v77
    v_add_f32 v13, v13, v81
    v_add_f32 v13, v13, v85
    v_add_f32 v13, v13, v89
    v_add_f32 v13, v13, v93
    v_add_f32 v13, v13, v97
    v_add_f32 v13, v13, v101
    v_add_f32 v14, v74, v78
    v_add_f32 v14, v14, v82
    v_add_f32 v14, v14, v86
    v_add_f32 v14, v14, v90
    v_add_f32 v14, v14, v94
    v_add_f32 v14, v14, v98
    v_add_f32 v14, v14, v102
    v_add_f32 v15, v120, v122
    v_add_f32 v15, v15, v124
    v_add_f32 v15, v15, v126
    v_add_f32 v15, v15, v128
    v_add_f32 v15, v15, v130
    v_add_f32 v15, v15, v132
    v_add_f32 v15, v15, v134
    v_cvt_pk_bf16_f32 v12, v12, v13
    v_cvt_pk_bf16_f32 v14, v14, v15
    ds_write_b16 v8, v12 offset:4608
    ds_write_b16_d16_hi v8, v12 offset:4624
    ds_write_b16 v8, v14 offset:4640
    ds_write_b16_d16_hi v8, v14 offset:4656
    s_waitcnt lgkmcnt(0)
    v_mov_b32 v6, 6720
    v_mov_b32 v7, 1
    s_mov_b64 exec, 1
    ds_add_u32 v6, v7
    s_mov_b64 exec, -1
    s_cmp_lt_u32 s89, 32
    s_cbranch_scc1 L_A0_FIN
    s_sub_u32 s48, s89, 32
    s_lshr_b32 s49, s48, 3
    s_lshl_b32 s49, s49, 18
    s_and_b32 s48, s48, 7
    s_lshl_b32 s48, s48, 8
    s_add_u32 s48, s48, s49
    v_lshlrev_b32 v1, 14, v4
    v_lshl_add_u32 v1, v5, 4, v1
    v_mov_b32 v6, 6756
    s_mov_b32 s51, 4000000
LW_28:
    ds_read_b32 v7, v6
    s_waitcnt lgkmcnt(0)
    v_readfirstlane_b32 s50, v7
    s_cmp_ge_u32 s50, 4
    s_cbranch_scc1 LWD_29
    s_sleep 1
    s_sub_u32 s51, s51, 1
    s_cmp_lg_u32 s51, 0
    s_cbranch_scc1 LW_28
LWD_29:
    s_add_u32 s46, s48, 0
    buffer_load_dwordx4 v[72:75], v1, s[32:35], s46 offen nt
    s_add_u32 s46, s48, 2048
    buffer_load_dwordx4 v[76:79], v1, s[32:35], s46 offen nt
    s_add_u32 s46, s48, 4096
    buffer_load_dwordx4 v[80:83], v1, s[32:35], s46 offen nt
    s_add_u32 s46, s48, 6144
    buffer_load_dwordx4 v[84:87], v1, s[32:35], s46 offen nt
    s_add_u32 s46, s48, 8192
    buffer_load_dwordx4 v[88:91], v1, s[32:35], s46 offen nt
    s_add_u32 s46, s48, 10240
    buffer_load_dwordx4 v[92:95], v1, s[32:35], s46 offen nt
    s_add_u32 s46, s48, 12288
    buffer_load_dwordx4 v[96:99], v1, s[32:35], s46 offen nt
    s_add_u32 s46, s48, 14336
    buffer_load_dwordx4 v[100:103], v1, s[32:35], s46 offen nt
    s_add_u32 s46, s48, 65536
    buffer_load_dwordx4 v[104:107], v1, s[32:35], s46 offen nt
    s_add_u32 s46, s48, 67584
    buffer_load_dwordx4 v[108:111], v1, s[32:35], s46 offen nt
    s_add_u32 s46, s48, 69632
    buffer_load_dwordx4 v[112:115], v1, s[32:35], s46 offen nt
    s_add_u32 s46, s48, 71680
    buffer_load_dwordx4 v[116:119], v1, s[32:35], s46 offen nt
    s_add_u32 s46, s48, 73728
    buffer_load_dwordx4 v[120:123], v1, s[32:35], s46 offen nt
    s_add_u32 s46, s48, 75776
    buffer_load_dwordx4 v[124:127], v1, s[32:35], s46 offen nt
    s_add_u32 s46, s48, 77824
    buffer_load_dwordx4 v[128:131], v1, s[32:35], s46 offen nt
    s_add_u32 s46, s48, 79872
    buffer_load_dwordx4 v[132:135], v1, s[32:35], s46 offen nt
    s_add_u32 s46, s48, 131072
    buffer_load_dwordx4 v[136:139], v1, s[32:35], s46 offen nt
    s_add_u32 s46, s48, 133120
    buffer_load_dwordx4 v[140:143], v1, s[32:35], s46 offen nt
    s_add_u32 s46, s48, 135168
    buffer_load_dwordx4 v[144:147], v1, s[32:35], s46 offen nt
    s_add_u32 s46, s48, 137216
    buffer_load_dwordx4 v[148:151], v1, s[32:35], s46 offen nt
    s_add_u32 s46, s48, 139264
    buffer_load_dwordx4 v[152:155], v1, s[32:35], s46 offen nt
    s_add_u32 s46, s48, 141312
    buffer_load_dwordx4 v[156:159], v1, s[32:35], s46 offen nt
    s_add_u32 s46, s48, 143360
    buffer_load_dwordx4 v[160:163], v1, s[32:35], s46 offen nt
    s_add_u32 s46, s48, 145408
    buffer_load_dwordx4 v[164:167], v1, s[32:35], s46 offen nt
    v_and_b32 v3, 1, v0
    v_lshlrev_b32 v3, 8, v3
    v_lshl_add_u32 v3, v4, 4, v3
    v_add_u32 v3, 7424, v3
    v_mov_b32 v6, 6740
    s_mov_b32 s51, 4000000
LW_30:
    ds_read_b32 v7, v6
    s_waitcnt lgkmcnt(0)
    v_readfirstlane_b32 s50, v7
    s_cmp_ge_u32 s50, 1
    s_cbranch_scc1 LWD_31
    s_sleep 1
    s_sub_u32 s51, s51, 1
    s_cmp_lg_u32 s51, 0
    s_cbranch_scc1 LW_30
LWD_31:
    ds_read_b128 v[24:27], v3 offset:0
    ds_read_b128 v[28:31], v3 offset:64
    ds_read_b128 v[32:35], v3 offset:128
    ds_read_b128 v[36:39], v3 offset:192
    s_waitcnt lgkmcnt(0)
    s_waitcnt vmcnt(16)
    v_perm_b32 v8, v76, v72, s58
    v_perm_b32 v9, v84, v80, s58
    v_perm_b32 v10, v92, v88, s58
    v_perm_b32 v11, v100, v96, s58
    v_perm_b32 v12, v76, v72, s59
    v_perm_b32 v13, v84, v80, s59
    v_perm_b32 v14, v92, v88, s59
    v_perm_b32 v15, v100, v96, s59
    v_perm_b32 v16, v77, v73, s58
    v_perm_b32 v17, v85, v81, s58
    v_perm_b32 v18, v93, v89, s58
    v_perm_b32 v19, v101, v97, s58
    v_perm_b32 v20, v77, v73, s59
    v_perm_b32 v21, v85, v81, s59
    v_perm_b32 v22, v93, v89, s59
    v_perm_b32 v23, v101, v97, s59
    s_nop 1
    v_mfma_f32_16x16x32_bf16 v[40:43], v[8:11], v[24:27], 0
    v_mfma_f32_16x16x32_bf16 v[44:47], v[12:15], v[24:27], 0
    v_mfma_f32_16x16x32_bf16 v[48:51], v[16:19], v[24:27], 0
    v_mfma_f32_16x16x32_bf16 v[52:55], v[20:23], v[24:27], 0
    v_perm_b32 v8, v78, v74, s58
    v_perm_b32 v9, v86, v82, s58
    v_perm_b32 v10, v94, v90, s58
    v_perm_b32 v11, v102, v98, s58
    v_perm_b32 v12, v78, v74, s59
    v_perm_b32 v13, v86, v82, s59
    v_perm_b32 v14, v94, v90, s59
    v_perm_b32 v15, v102, v98, s59
    v_perm_b32 v16, v79, v75, s58
    v_perm_b32 v17, v87, v83, s58
    v_perm_b32 v18, v95, v91, s58
    v_perm_b32 v19, v103, v99, s58
    v_perm_b32 v20, v79, v75, s59
    v_perm_b32 v21, v87, v83, s59
    v_perm_b32 v22, v95, v91, s59
    v_perm_b32 v23, v103, v99, s59
    s_nop 1
    v_mfma_f32_16x16x32_bf16 v[56:59], v[8:11], v[24:27], 0
    v_mfma_f32_16x16x32_bf16 v[60:63], v[12:15], v[24:27], 0
    v_mfma_f32_16x16x32_bf16 v[64:67], v[16:19], v[24:27], 0
    v_mfma_f32_16x16x32_bf16 v[68:71], v[20:23], v[24:27], 0
    s_add_u32 s46, s48, 196608
    buffer_load_dwordx4 v[72:75], v1, s[32:35], s46 offen nt
    s_add_u32 s46, s48, 198656
    buffer_load_dwordx4 v[76:79], v1, s[32:35], s46 offen nt
    s_add_u32 s46, s48, 200704
    buffer_load_dwordx4 v[80:83], v1, s[32:35], s46 offen nt
    s_add_u32 s46, s48, 202752
    buffer_load_dwordx4 v[84:87], v1, s[32:35], s46 offen nt
    s_add_u32 s46, s48, 204800
    buffer_load_dwordx4 v[88:91], v1, s[32:35], s46 offen nt
    s_add_u32 s46, s48, 206848
    buffer_load_dwordx4 v[92:95], v1, s[32:35], s46 offen nt
    s_add_u32 s46, s48, 208896
    buffer_load_dwordx4 v[96:99], v1, s[32:35], s46 offen nt
    s_add_u32 s46, s48, 210944
    buffer_load_dwordx4 v[100:103], v1, s[32:35], s46 offen nt
    s_waitcnt vmcnt(16)
    v_perm_b32 v8, v108, v104, s58
    v_perm_b32 v9, v116, v112, s58
    v_perm_b32 v10, v124, v120, s58
    v_perm_b32 v11, v132, v128, s58
    v_perm_b32 v12, v108, v104, s59
    v_perm_b32 v13, v116, v112, s59
    v_perm_b32 v14, v124, v120, s59
    v_perm_b32 v15, v132, v128, s59
    v_perm_b32 v16, v109, v105, s58
    v_perm_b32 v17, v117, v113, s58
    v_perm_b32 v18, v125, v121, s58
    v_perm_b32 v19, v133, v129, s58
    v_perm_b32 v20, v109, v105, s59
    v_perm_b32 v21, v117, v113, s59
    v_perm_b32 v22, v125, v121, s59
    v_perm_b32 v23, v133, v129, s59
    s_nop 1
    v_mfma_f32_16x16x32_bf16 v[40:43], v[8:11], v[28:31], v[40:43]
    v_mfma_f32_16x16x32_bf16 v[44:47], v[12:15], v[28:31], v[44:47]
    v_mfma_f32_16x16x32_bf16 v[48:51], v[16:19], v[28:31], v[48:51]
    v_mfma_f32_16x16x32_bf16 v[52:55], v[20:23], v[28:31], v[52:55]
    v_perm_b32 v8, v110, v106, s58
    v_perm_b32 v9, v118, v114, s58
    v_perm_b32 v10, v126, v122, s58
    v_perm_b32 v11, v134, v130, s58
    v_perm_b32 v12, v110, v106, s59
    v_perm_b32 v13, v118, v114, s59
    v_perm_b32 v14, v126, v122, s59
    v_perm_b32 v15, v134, v130, s59
    v_perm_b32 v16, v111, v107, s58
    v_perm_b32 v17, v119, v115, s58
    v_perm_b32 v18, v127, v123, s58
    v_perm_b32 v19, v135, v131, s58
    v_perm_b32 v20, v111, v107, s59
    v_perm_b32 v21, v119, v115, s59
    v_perm_b32 v22, v127, v123, s59
    v_perm_b32 v23, v135, v131, s59
    s_nop 1
    v_mfma_f32_16x16x32_bf16 v[56:59], v[8:11], v[28:31], v[56:59]
    v_mfma_f32_16x16x32_bf16 v[60:63], v[12:15], v[28:31], v[60:63]
    v_mfma_f32_16x16x32_bf16 v[64:67], v[16:19], v[28:31], v[64:67]
    v_mfma_f32_16x16x32_bf16 v[68:71], v[20:23], v[28:31], v[68:71]
    s_waitcnt vmcnt(8)
    v_perm_b32 v8, v140, v136, s58
    v_perm_b32 v9, v148, v144, s58
    v_perm_b32 v10, v156, v152, s58
    v_perm_b32 v11, v164, v160, s58
    v_perm_b32 v12, v140, v136, s59
    v_perm_b32 v13, v148, v144, s59
    v_perm_b32 v14, v156, v152, s59
    v_perm_b32 v15, v164, v160, s59
    v_perm_b32 v16, v141, v137, s58
    v_perm_b32 v17, v149, v145, s58
    v_perm_b32 v18, v157, v153, s58
    v_perm_b32 v19, v165, v161, s58
    v_perm_b32 v20, v141, v137, s59
    v_perm_b32 v21, v149, v145, s59
    v_perm_b32 v22, v157, v153, s59
    v_perm_b32 v23, v165, v161, s59
    s_nop 1
    v_mfma_f32_16x16x32_bf16 v[40:43], v[8:11], v[32:35], v[40:43]
    v_mfma_f32_16x16x32_bf16 v[44:47], v[12:15], v[32:35], v[44:47]
    v_mfma_f32_16x16x32_bf16 v[48:51], v[16:19], v[32:35], v[48:51]
    v_mfma_f32_16x16x32_bf16 v[52:55], v[20:23], v[32:35], v[52:55]
    v_perm_b32 v8, v142, v138, s58
    v_perm_b32 v9, v150, v146, s58
    v_perm_b32 v10, v158, v154, s58
    v_perm_b32 v11, v166, v162, s58
    v_perm_b32 v12, v142, v138, s59
    v_perm_b32 v13, v150, v146, s59
    v_perm_b32 v14, v158, v154, s59
    v_perm_b32 v15, v166, v162, s59
    v_perm_b32 v16, v143, v139, s58
    v_perm_b32 v17, v151, v147, s58
    v_perm_b32 v18, v159, v155, s58
    v_perm_b32 v19, v167, v163, s58
    v_perm_b32 v20, v143, v139, s59
    v_perm_b32 v21, v151, v147, s59
    v_perm_b32 v22, v159, v155, s59
    v_perm_b32 v23, v167, v163, s59
    s_nop 1
    v_mfma_f32_16x16x32_bf16 v[56:59], v[8:11], v[32:35], v[56:59]
    v_mfma_f32_16x16x32_bf16 v[60:63], v[12:15], v[32:35], v[60:63]
    v_mfma_f32_16x16x32_bf16 v[64:67], v[16:19], v[32:35], v[64:67]
    v_mfma_f32_16x16x32_bf16 v[68:71], v[20:23], v[32:35], v[68:71]
    s_waitcnt vmcnt(0)
    v_perm_b32 v8, v76, v72, s58
    v_perm_b32 v9, v84, v80, s58
    v_perm_b32 v10, v92, v88, s58
    v_perm_b32 v11, v100, v96, s58
    v_perm_b32 v12, v76, v72, s59
    v_perm_b32 v13, v84, v80, s59
    v_perm_b32 v14, v92, v88, s59
    v_perm_b32 v15, v100, v96, s59
    v_perm_b32 v16, v77, v73, s58
    v_perm_b32 v17, v85, v81, s58
    v_perm_b32 v18, v93, v89, s58
    v_perm_b32 v19, v101, v97, s58
    v_perm_b32 v20, v77, v73, s59
    v_perm_b32 v21, v85, v81, s59
    v_perm_b32 v22, v93, v89, s59
    v_perm_b32 v23, v101, v97, s59
    s_nop 1
    v_mfma_f32_16x16x32_bf16 v[40:43], v[8:11], v[36:39], v[40:43]
    v_mfma_f32_16x16x32_bf16 v[44:47], v[12:15], v[36:39], v[44:47]
    v_mfma_f32_16x16x32_bf16 v[48:51], v[16:19], v[36:39], v[48:51]
    v_mfma_f32_16x16x32_bf16 v[52:55], v[20:23], v[36:39], v[52:55]
    v_perm_b32 v8, v78, v74, s58
    v_perm_b32 v9, v86, v82, s58
    v_perm_b32 v10, v94, v90, s58
    v_perm_b32 v11, v102, v98, s58
    v_perm_b32 v12, v78, v74, s59
    v_perm_b32 v13, v86, v82, s59
    v_perm_b32 v14, v94, v90, s59
    v_perm_b32 v15, v102, v98, s59
    v_perm_b32 v16, v79, v75, s58
    v_perm_b32 v17, v87, v83, s58
    v_perm_b32 v18, v95, v91, s58
    v_perm_b32 v19, v103, v99, s58
    v_perm_b32 v20, v79, v75, s59
    v_perm_b32 v21, v87, v83, s59
    v_perm_b32 v22, v95, v91, s59
    v_perm_b32 v23, v103, v99, s59
    s_nop 1
    v_mfma_f32_16x16x32_bf16 v[56:59], v[8:11], v[36:39], v[56:59]
    v_mfma_f32_16x16x32_bf16 v[60:63], v[12:15], v[36:39], v[60:63]
    v_mfma_f32_16x16x32_bf16 v[64:67], v[16:19], v[36:39], v[64:67]
    v_mfma_f32_16x16x32_bf16 v[68:71], v[20:23], v[36:39], v[68:71]
    v_and_b32 v2, 1, v0
    v_lshlrev_b32 v2, 14, v2
    v_lshl_add_u32 v2, v4, 7, v2
    v_bfe_u32 v6, v0, 1, 3
    v_lshl_add_u32 v2, v6, 4, v2
    s_nop 7
    s_nop 1
    v_cndmask_b32 v40, v40, v44, s[80:81]
    v_cndmask_b32 v41, v41, v45, s[80:81]
    v_cndmask_b32 v42, v42, v46, s[80:81]
    v_cndmask_b32 v43, v43, v47, s[80:81]
    v_cndmask_b32 v48, v48, v52, s[80:81]
    v_cndmask_b32 v49, v49, v53, s[80:81]
    v_cndmask_b32 v50, v50, v54, s[80:81]
    v_cndmask_b32 v51, v51, v55, s[80:81]
    v_cndmask_b32 v56, v56, v60, s[80:81]
    v_cndmask_b32 v57, v57, v61, s[80:81]
    v_cndmask_b32 v58, v58, v62, s[80:81]
    v_cndmask_b32 v59, v59, v63, s[80:81]
    v_cndmask_b32 v64, v64, v68, s[80:81]
    v_cndmask_b32 v65, v65, v69, s[80:81]
    v_cndmask_b32 v66, v66, v70, s[80:81]
    v_cndmask_b32 v67, v67, v71, s[80:81]
    v_cndmask_b32 v40, v40, v48, s[82:83]
    v_cndmask_b32 v41, v41, v49, s[82:83]
    v_cndmask_b32 v42, v42, v50, s[82:83]
    v_cndmask_b32 v43, v43, v51, s[82:83]
    v_cndmask_b32 v56, v56, v64, s[82:83]
    v_cndmask_b32 v57, v57, v65, s[82:83]
    v_cndmask_b32 v58, v58, v66, s[82:83]
    v_cndmask_b32 v59, v59, v67, s[82:83]
    v_cndmask_b32 v40, v40, v56, s[84:85]
    v_cndmask_b32 v41, v41, v57, s[84:85]
    v_cndmask_b32 v42, v42, v58, s[84:85]
    v_cndmask_b32 v43, v43, v59, s[84:85]
    buffer_store_dwordx4 v[40:43], v2, s[36:39], s56 offen sc1
L_A0_FIN:
    s_mov_b32 s28, s4
    s_mov_b32 s29, s5
    s_mov_b32 s30, 4096
    s_mov_b32 s31, 0x20000
    s_mov_b32 s32, s22
    s_mov_b32 s33, s23
    s_mov_b32 s34, 4096
    s_mov_b32 s35, 0x20000
    s_lshr_b32 s44, s2, 5
    s_bfe_u32 s45, s2, 0x10004
    s_and_b32 s46, s2, 15
    s_lshr_b32 s48, s2, 4
    s_lshl_b32 s49, s48, 14
    s_lshl_b32 s48, s48, 15
    s_lshl_b32 s53, s46, 5
    s_add_u32 s48, s48, s53
    s_add_u32 s49, s49, s53
    s_add_u32 s48, s48, 786432
    s_add_u32 s49, s49, 1310720
    v_lshrrev_b32 v2, 1, v0
    v_and_b32 v3, 1, v0
    v_lshlrev_b32 v1, 10, v2
    v_lshl_add_u32 v1, v3, 4, v1
    v_min_u32 v2, 27, v2
    v_lshlrev_b32 v2, 9, v2
    v_lshl_add_u32 v2, v3, 4, v2
    s_lshl_b32 s52, s45, 10
    s_lshl_b32 s53, s44, 7
    s_add_u32 s52, s52, s53
    s_lshr_b32 s53, s46, 2
    s_lshl_b32 s53, s53, 5
    s_add_u32 s52, s52, s53
    s_and_b32 s53, s46, 3
    s_lshl_b32 s53, s53, 1
    s_add_u32 s52, s52, s53
    v_add_u32 v4, s52, v3
    v_lshlrev_b32 v4, 1, v4
    buffer_load_ushort v24, v4, s[28:31], 0 offen
    buffer_load_ushort v25, v4, s[28:31], 0 offen offset:16
    buffer_load_ushort v26, v4, s[28:31], 0 offen offset:32
    buffer_load_ushort v27, v4, s[28:31], 0 offen offset:48
    v_lshlrev_b32 v3, 7, v0
    v_lshlrev_b32 v6, 6, v0
    v_lshrrev_b32 v6, 0, v6
    s_nop 0
    s_mov_b32 s46, 2883712
    s_mov_b32 s51, 40000
    s_mov_b64 exec, 15
F4_32:
    buffer_load_dword v9, v3, s[36:39], s46 offen sc1
    buffer_load_dword v7, v6, s[40:43], 0 offen sc1
    s_waitcnt vmcnt(0)
    v_cmp_ne_u32 vcc, v9, v7
    v_cmp_eq_u32 s[52:53], 0, v7
    s_or_b64 vcc, vcc, s[52:53]
    s_cbranch_vccz F4D_33
    s_sleep 16
    s_sub_u32 s51, s51, 1
    s_cmp_lg_u32 s51, 0
    s_cbranch_scc1 F4_32
F4D_33:
    s_mov_b64 exec, -1
    v_mov_b32 v6, 6760
    s_mov_b32 s51, 4000000
LW_34:
    ds_read_b32 v7, v6
    s_waitcnt lgkmcnt(0)
    v_readfirstlane_b32 s50, v7
    s_cmp_ge_u32 s50, 2
    s_cbranch_scc1 LWD_35
    s_sleep 1
    s_sub_u32 s51, s51, 1
    s_cmp_lg_u32 s51, 0
    s_cbranch_scc1 LW_34
LWD_35:
    s_mov_b32 s51, 40000
PL_36:
    buffer_load_dwordx4 v[8:11], v1, s[36:39], s48 offen sc1
    buffer_load_dwordx4 v[12:15], v1, s[36:39], s48 offen offset:512 sc1
    buffer_load_dwordx4 v[16:19], v2, s[36:39], s49 offen sc1
    s_waitcnt vmcnt(0)
    v_max_u32 v7, v8, v9
    v_max3_u32 v7, v7, v10, v11
    v_max3_u32 v7, v7, v12, v13
    v_max3_u32 v7, v7, v14, v15
    v_max3_u32 v7, v7, v16, v17
    v_max3_u32 v7, v7, v18, v19
    v_cmp_eq_u32 vcc, -1, v7
    s_cbranch_vccz PLD_37
    s_sleep 1
    s_sub_u32 s51, s51, 1
    s_cmp_lg_u32 s51, 0
    s_cbranch_scc1 PL_36
PLD_37:
    v_cmp_gt_u32 vcc, 56, v0
    s_nop 1
    v_add_f32 v8, v8, v12
    v_cndmask_b32 v16, 0, v16, vcc
    v_add_f32 v9, v9, v13
    v_cndmask_b32 v17, 0, v17, vcc
    v_add_f32 v10, v10, v14
    v_cndmask_b32 v18, 0, v18, vcc
    v_add_f32 v11, v11, v15
    v_cndmask_b32 v19, 0, v19, vcc
    s_nop 1
    v_add_f32_dpp v40, v8, v8 row_ror:2 row_mask:0xf bank_mask:0xf
    v_add_f32_dpp v41, v9, v9 row_ror:2 row_mask:0xf bank_mask:0xf
    v_add_f32_dpp v42, v10, v10 row_ror:2 row_mask:0xf bank_mask:0xf
    v_add_f32_dpp v43, v11, v11 row_ror:2 row_mask:0xf bank_mask:0xf
    v_add_f32_dpp v44, v16, v16 row_ror:2 row_mask:0xf bank_mask:0xf
    v_add_f32_dpp v45, v17, v17 row_ror:2 row_mask:0xf bank_mask:0xf
    v_add_f32_dpp v46, v18, v18 row_ror:2 row_mask:0xf bank_mask:0xf
    v_add_f32_dpp v47, v19, v19 row_ror:2 row_mask:0xf bank_mask:0xf
    v_add_f32_dpp v8, v40, v40 row_ror:4 row_mask:0xf bank_mask:0xf
    v_add_f32_dpp v9, v41, v41 row_ror:4 row_mask:0xf bank_mask:0xf
    v_add_f32_dpp v10, v42, v42 row_ror:4 row_mask:0xf bank_mask:0xf
    v_add_f32_dpp v11, v43, v43 row_ror:4 row_mask:0xf bank_mask:0xf
    v_add_f32_dpp v16, v44, v44 row_ror:4 row_mask:0xf bank_mask:0xf
    v_add_f32_dpp v17, v45, v45 row_ror:4 row_mask:0xf bank_mask:0xf
    v_add_f32_dpp v18, v46, v46 row_ror:4 row_mask:0xf bank_mask:0xf
    v_add_f32_dpp v19, v47, v47 row_ror:4 row_mask:0xf bank_mask:0xf
    v_add_f32_dpp v40, v8, v8 row_ror:8 row_mask:0xf bank_mask:0xf
    v_add_f32_dpp v41, v9, v9 row_ror:8 row_mask:0xf bank_mask:0xf
    v_add_f32_dpp v42, v10, v10 row_ror:8 row_mask:0xf bank_mask:0xf
    v_add_f32_dpp v43, v11, v11 row_ror:8 row_mask:0xf bank_mask:0xf
    v_add_f32_dpp v44, v16, v16 row_ror:8 row_mask:0xf bank_mask:0xf
    v_add_f32_dpp v45, v17, v17 row_ror:8 row_mask:0xf bank_mask:0xf
    v_add_f32_dpp v46, v18, v18 row_ror:8 row_mask:0xf bank_mask:0xf
    v_add_f32_dpp v47, v19, v19 row_ror:8 row_mask:0xf bank_mask:0xf
    v_mov_b32 v8, v40
    v_mov_b32 v9, v41
    v_mov_b32 v10, v42
    v_mov_b32 v11, v43
    v_mov_b32 v16, v44
    v_mov_b32 v17, v45
    v_mov_b32 v18, v46
    v_mov_b32 v19, v47
    v_permlane16_swap_b32 v40, v8
    v_permlane16_swap_b32 v41, v9
    v_permlane16_swap_b32 v42, v10
    v_permlane16_swap_b32 v43, v11
    v_permlane16_swap_b32 v44, v16
    v_permlane16_swap_b32 v45, v17
    v_permlane16_swap_b32 v46, v18
    v_permlane16_swap_b32 v47, v19
    v_add_f32 v40, v40, v8
    v_add_f32 v41, v41, v9
    v_add_f32 v42, v42, v10
    v_add_f32 v43, v43, v11
    v_add_f32 v44, v44, v16
    v_add_f32 v45, v45, v17
    v_add_f32 v46, v46, v18
    v_add_f32 v47, v47, v19
    v_mov_b32 v8, v40
    v_mov_b32 v9, v41
    v_mov_b32 v10, v42
    v_mov_b32 v11, v43
    v_mov_b32 v16, v44
    v_mov_b32 v17, v45
    v_mov_b32 v18, v46
    v_mov_b32 v19, v47
    v_permlane32_swap_b32 v40, v8
    v_permlane32_swap_b32 v41, v9
    v_permlane32_swap_b32 v42, v10
    v_permlane32_swap_b32 v43, v11
    v_permlane32_swap_b32 v44, v16
    v_permlane32_swap_b32 v45, v17
    v_permlane32_swap_b32 v46, v18
    v_permlane32_swap_b32 v47, v19
    v_add_f32 v40, v40, v8
    v_add_f32 v41, v41, v9
    v_add_f32 v42, v42, v10
    v_add_f32 v43, v43, v11
    v_add_f32 v44, v44, v16
    v_add_f32 v45, v45, v17
    v_add_f32 v46, v46, v18
    v_add_f32 v47, v47, v19
    v_mov_b32 v8, v40
    v_mov_b32 v9, v41
    v_mov_b32 v10, v42
    v_mov_b32 v11, v43
    v_mov_b32 v16, v44
    v_mov_b32 v17, v45
    v_mov_b32 v18, v46
    v_mov_b32 v19, v47
    v_cvt_pk_bf16_f32 v20, v8, v9
    v_lshlrev_b32 v8, 16, v20
    v_and_b32 v9, 0xffff0000, v20
    v_cvt_pk_bf16_f32 v20, v10, v11
    v_lshlrev_b32 v10, 16, v20
    v_and_b32 v11, 0xffff0000, v20
    v_cvt_pk_bf16_f32 v20, v16, v17
    v_lshlrev_b32 v16, 16, v20
    v_and_b32 v17, 0xffff0000, v20
    v_cvt_pk_bf16_f32 v20, v18, v19
    v_lshlrev_b32 v18, 16, v20
    v_and_b32 v19, 0xffff0000, v20
    v_mul_f32 v20, s60, v16
    v_exp_f32 v20, -v20
    s_nop 0
    v_add_f32 v20, 1.0, v20
    v_rcp_f32 v21, v20
    s_nop 0
    v_mul_f32 v22, v16, v21
    v_fma_f32 v20, -v22, v20, v16
    v_fma_f32 v20, v20, v21, v22
    v_cmp_eq_f32 vcc, 0, v21
    s_nop 1
    v_cndmask_b32 v16, v20, v22, vcc
    v_mul_f32 v20, s60, v17
    v_exp_f32 v20, -v20
    s_nop 0
    v_add_f32 v20, 1.0, v20
    v_rcp_f32 v21, v20
    s_nop 0
    v_mul_f32 v22, v17, v21
    v_fma_f32 v20, -v22, v20, v17
    v_fma_f32 v20, v20, v21, v22
    v_cmp_eq_f32 vcc, 0, v21
    s_nop 1
    v_cndmask_b32 v17, v20, v22, vcc
    v_mul_f32 v20, s60, v18
    v_exp_f32 v20, -v20
    s_nop 0
    v_add_f32 v20, 1.0, v20
    v_rcp_f32 v21, v20
    s_nop 0
    v_mul_f32 v22, v18, v21
    v_fma_f32 v20, -v22, v20, v18
    v_fma_f32 v20, v20, v21, v22
    v_cmp_eq_f32 vcc, 0, v21
    s_nop 1
    v_cndmask_b32 v18, v20, v22, vcc
    v_mul_f32 v20, s60, v19
    v_exp_f32 v20, -v20
    s_nop 0
    v_add_f32 v20, 1.0, v20
    v_rcp_f32 v21, v20
    s_nop 0
    v_mul_f32 v22, v19, v21
    v_fma_f32 v20, -v22, v20, v19
    v_fma_f32 v20, v20, v21, v22
    v_cmp_eq_f32 vcc, 0, v21
    s_nop 1
    v_cndmask_b32 v19, v20, v22, vcc
    v_cvt_pk_bf16_f32 v20, v16, v17
    v_lshlrev_b32 v16, 16, v20
    v_and_b32 v17, 0xffff0000, v20
    v_cvt_pk_bf16_f32 v20, v18, v19
    v_lshlrev_b32 v18, 16, v20
    v_and_b32 v19, 0xffff0000, v20
    v_mul_f32 v8, v8, v16
    v_mul_f32 v9, v9, v17
    v_mul_f32 v10, v10, v18
    v_mul_f32 v11, v11, v19
    v_cvt_pk_bf16_f32 v20, v8, v9
    v_lshlrev_b32 v8, 16, v20
    v_and_b32 v9, 0xffff0000, v20
    v_cvt_pk_bf16_f32 v20, v10, v11
    v_lshlrev_b32 v10, 16, v20
    v_and_b32 v11, 0xffff0000, v20
    v_lshlrev_b32 v24, 16, v24
    v_add_f32 v8, v8, v24
    v_cvt_pk_bf16_f32 v8, v8, v8
    v_lshlrev_b32 v25, 16, v25
    v_add_f32 v9, v9, v25
    v_cvt_pk_bf16_f32 v9, v9, v9
    v_lshlrev_b32 v26, 16, v26
    v_add_f32 v10, v10, v26
    v_cvt_pk_bf16_f32 v10, v10, v10
    v_lshlrev_b32 v27, 16, v27
    v_add_f32 v11, v11, v27
    v_cvt_pk_bf16_f32 v11, v11, v11
    s_mov_b64 exec, 3
    buffer_store_short v8, v4, s[32:35], 0 offen
    buffer_store_short v9, v4, s[32:35], 0 offen offset:16
    buffer_store_short v10, v4, s[32:35], 0 offen offset:32
    buffer_store_short v11, v4, s[32:35], 0 offen offset:48
    s_endpgm
L_A12:
    s_cmp_eq_u32 s3, 1
    s_cselect_b32 s28, s16, s18
    s_cselect_b32 s29, s17, s19
    s_mov_b32 s30, 7340032
    s_mov_b32 s31, 0x20000
    v_lshrrev_b32 v4, 4, v0
    v_and_b32 v5, 15, v0
    s_and_b32 s44, s2, 7
    s_mul_i32 s45, s44, 917504
    s_lshr_b32 s46, s2, 3
    s_lshl_b32 s46, s46, 8
    s_add_u32 s45, s45, s46
    v_mul_u32_u24 v1, 57344, v4
    v_lshl_add_u32 v1, v5, 4, v1
    v_and_b32 v2, 1, v0
    v_lshlrev_b32 v3, 11, v2
    v_lshl_add_u32 v3, v4, 4, v3
    s_lshl_b32 s46, s44, 8
    v_add_u32 v3, s46, v3
    v_lshlrev_b32 v2, 9, v2
    v_lshl_add_u32 v2, v4, 7, v2
    v_bfe_u32 v6, v0, 1, 3
    v_lshl_add_u32 v2, v6, 4, v2
    s_cmp_ge_u32 s2, 224
    s_cbranch_scc1 L_A12_SKIP
    s_barrier
    v_mov_b32 v6, 6748
    s_mov_b32 s51, 4000000
LW_38:
    ds_read_b32 v7, v6
    s_waitcnt lgkmcnt(0)
    v_readfirstlane_b32 s50, v7
    s_cmp_ge_u32 s50, 4
    s_cbranch_scc1 LWD_39
    s_sleep 1
    s_sub_u32 s51, s51, 1
    s_cmp_lg_u32 s51, 0
    s_cbranch_scc1 LW_38
LWD_39:
    s_add_u32 s46, s45, 0
    buffer_load_dwordx4 v[72:75], v1, s[28:31], s46 offen nt
    s_add_u32 s46, s45, 7168
    buffer_load_dwordx4 v[76:79], v1, s[28:31], s46 offen nt
    s_add_u32 s46, s45, 14336
    buffer_load_dwordx4 v[80:83], v1, s[28:31], s46 offen nt
    s_add_u32 s46, s45, 21504
    buffer_load_dwordx4 v[84:87], v1, s[28:31], s46 offen nt
    s_add_u32 s46, s45, 28672
    buffer_load_dwordx4 v[88:91], v1, s[28:31], s46 offen nt
    s_add_u32 s46, s45, 35840
    buffer_load_dwordx4 v[92:95], v1, s[28:31], s46 offen nt
    s_add_u32 s46, s45, 43008
    buffer_load_dwordx4 v[96:99], v1, s[28:31], s46 offen nt
    s_add_u32 s46, s45, 50176
    buffer_load_dwordx4 v[100:103], v1, s[28:31], s46 offen nt
    s_add_u32 s46, s45, 229376
    buffer_load_dwordx4 v[104:107], v1, s[28:31], s46 offen nt
    s_add_u32 s46, s45, 236544
    buffer_load_dwordx4 v[108:111], v1, s[28:31], s46 offen nt
    s_add_u32 s46, s45, 243712
    buffer_load_dwordx4 v[112:115], v1, s[28:31], s46 offen nt
    s_add_u32 s46, s45, 250880
    buffer_load_dwordx4 v[116:119], v1, s[28:31], s46 offen nt
    s_add_u32 s46, s45, 258048
    buffer_load_dwordx4 v[120:123], v1, s[28:31], s46 offen nt
    s_add_u32 s46, s45, 265216
    buffer_load_dwordx4 v[124:127], v1, s[28:31], s46 offen nt
    s_add_u32 s46, s45, 272384
    buffer_load_dwordx4 v[128:131], v1, s[28:31], s46 offen nt
    s_add_u32 s46, s45, 279552
    buffer_load_dwordx4 v[132:135], v1, s[28:31], s46 offen nt
    v_mov_b32 v6, 6752
    s_mov_b32 s51, 4000000
LW_40:
    ds_read_b32 v7, v6
    s_waitcnt lgkmcnt(0)
    v_readfirstlane_b32 s50, v7
    s_cmp_ge_u32 s50, 1
    s_cbranch_scc1 LWD_41
    s_sleep 1
    s_sub_u32 s51, s51, 1
    s_cmp_lg_u32 s51, 0
    s_cbranch_scc1 LW_40
LWD_41:
    ds_read_b128 v[24:27], v3 offset:0
    ds_read_b128 v[28:31], v3 offset:64
    ds_read_b128 v[32:35], v3 offset:128
    ds_read_b128 v[36:39], v3 offset:192
    s_waitcnt lgkmcnt(0)
    s_waitcnt vmcnt(8)
    s_add_u32 s46, s45, 458752
    buffer_load_dwordx4 v[136:139], v1, s[28:31], s46 offen nt
    s_add_u32 s46, s45, 465920
    buffer_load_dwordx4 v[140:143], v1, s[28:31], s46 offen nt
    s_add_u32 s46, s45, 473088
    buffer_load_dwordx4 v[144:147], v1, s[28:31], s46 offen nt
    s_add_u32 s46, s45, 480256
    buffer_load_dwordx4 v[148:151], v1, s[28:31], s46 offen nt
    s_add_u32 s46, s45, 487424
    buffer_load_dwordx4 v[152:155], v1, s[28:31], s46 offen nt
    s_add_u32 s46, s45, 494592
    buffer_load_dwordx4 v[156:159], v1, s[28:31], s46 offen nt
    s_add_u32 s46, s45, 501760
    buffer_load_dwordx4 v[160:163], v1, s[28:31], s46 offen nt
    s_add_u32 s46, s45, 508928
    buffer_load_dwordx4 v[164:167], v1, s[28:31], s46 offen nt
    v_perm_b32 v8, v76, v72, s58
    v_perm_b32 v9, v84, v80, s58
    v_perm_b32 v10, v92, v88, s58
    v_perm_b32 v11, v100, v96, s58
    v_perm_b32 v12, v76, v72, s59
    v_perm_b32 v13, v84, v80, s59
    v_perm_b32 v14, v92, v88, s59
    v_perm_b32 v15, v100, v96, s59
    v_perm_b32 v16, v77, v73, s58
    v_perm_b32 v17, v85, v81, s58
    v_perm_b32 v18, v93, v89, s58
    v_perm_b32 v19, v101, v97, s58
    v_perm_b32 v20, v77, v73, s59
    v_perm_b32 v21, v85, v81, s59
    v_perm_b32 v22, v93, v89, s59
    v_perm_b32 v23, v101, v97, s59
    s_nop 1
    v_mfma_f32_16x16x32_bf16 v[40:43], v[8:11], v[24:27], 0
    v_mfma_f32_16x16x32_bf16 v[44:47], v[12:15], v[24:27], 0
    v_mfma_f32_16x16x32_bf16 v[48:51], v[16:19], v[24:27], 0
    v_mfma_f32_16x16x32_bf16 v[52:55], v[20:23], v[24:27], 0
    v_perm_b32 v8, v78, v74, s58
    v_perm_b32 v9, v86, v82, s58
    v_perm_b32 v10, v94, v90, s58
    v_perm_b32 v11, v102, v98, s58
    v_perm_b32 v12, v78, v74, s59
    v_perm_b32 v13, v86, v82, s59
    v_perm_b32 v14, v94, v90, s59
    v_perm_b32 v15, v102, v98, s59
    v_perm_b32 v16, v79, v75, s58
    v_perm_b32 v17, v87, v83, s58
    v_perm_b32 v18, v95, v91, s58
    v_perm_b32 v19, v103, v99, s58
    v_perm_b32 v20, v79, v75, s59
    v_perm_b32 v21, v87, v83, s59
    v_perm_b32 v22, v95, v91, s59
    v_perm_b32 v23, v103, v99, s59
    s_nop 1
    v_mfma_f32_16x16x32_bf16 v[56:59], v[8:11], v[24:27], 0
    v_mfma_f32_16x16x32_bf16 v[60:63], v[12:15], v[24:27], 0
    v_mfma_f32_16x16x32_bf16 v[64:67], v[16:19], v[24:27], 0
    v_mfma_f32_16x16x32_bf16 v[68:71], v[20:23], v[24:27], 0
    s_waitcnt vmcnt(8)
    s_add_u32 s46, s45, 688128
    buffer_load_dwordx4 v[72:75], v1, s[28:31], s46 offen nt
    s_add_u32 s46, s45, 695296
    buffer_load_dwordx4 v[76:79], v1, s[28:31], s46 offen nt
    s_add_u32 s46, s45, 702464
    buffer_load_dwordx4 v[80:83], v1, s[28:31], s46 offen nt
    s_add_u32 s46, s45, 709632
    buffer_load_dwordx4 v[84:87], v1, s[28:31], s46 offen nt
    s_add_u32 s46, s45, 716800
    buffer_load_dwordx4 v[88:91], v1, s[28:31], s46 offen nt
    s_add_u32 s46, s45, 723968
    buffer_load_dwordx4 v[92:95], v1, s[28:31], s46 offen nt
    s_add_u32 s46, s45, 731136
    buffer_load_dwordx4 v[96:99], v1, s[28:31], s46 offen nt
    s_add_u32 s46, s45, 738304
    buffer_load_dwordx4 v[100:103], v1, s[28:31], s46 offen nt
    v_perm_b32 v8, v108, v104, s58
    v_perm_b32 v9, v116, v112, s58
    v_perm_b32 v10, v124, v120, s58
    v_perm_b32 v11, v132, v128, s58
    v_perm_b32 v12, v108, v104, s59
    v_perm_b32 v13, v116, v112, s59
    v_perm_b32 v14, v124, v120, s59
    v_perm_b32 v15, v132, v128, s59
    v_perm_b32 v16, v109, v105, s58
    v_perm_b32 v17, v117, v113, s58
    v_perm_b32 v18, v125, v121, s58
    v_perm_b32 v19, v133, v129, s58
    v_perm_b32 v20, v109, v105, s59
    v_perm_b32 v21, v117, v113, s59
    v_perm_b32 v22, v125, v121, s59
    v_perm_b32 v23, v133, v129, s59
    s_nop 1
    v_mfma_f32_16x16x32_bf16 v[40:43], v[8:11], v[28:31], v[40:43]
    v_mfma_f32_16x16x32_bf16 v[44:47], v[12:15], v[28:31], v[44:47]
    v_mfma_f32_16x16x32_bf16 v[48:51], v[16:19], v[28:31], v[48:51]
    v_mfma_f32_16x16x32_bf16 v[52:55], v[20:23], v[28:31], v[52:55]
    v_perm_b32 v8, v110, v106, s58
    v_perm_b32 v9, v118, v114, s58
    v_perm_b32 v10, v126, v122, s58
    v_perm_b32 v11, v134, v130, s58
    v_perm_b32 v12, v110, v106, s59
    v_perm_b32 v13, v118, v114, s59
    v_perm_b32 v14, v126, v122, s59
    v_perm_b32 v15, v134, v130, s59
    v_perm_b32 v16, v111, v107, s58
    v_perm_b32 v17, v119, v115, s58
    v_perm_b32 v18, v127, v123, s58
    v_perm_b32 v19, v135, v131, s58
    v_perm_b32 v20, v111, v107, s59
    v_perm_b32 v21, v119, v115, s59
    v_perm_b32 v22, v127, v123, s59
    v_perm_b32 v23, v135, v131, s59
    s_nop 1
    v_mfma_f32_16x16x32_bf16 v[56:59], v[8:11], v[28:31], v[56:59]
    v_mfma_f32_16x16x32_bf16 v[60:63], v[12:15], v[28:31], v[60:63]
    v_mfma_f32_16x16x32_bf16 v[64:67], v[16:19], v[28:31], v[64:67]
    v_mfma_f32_16x16x32_bf16 v[68:71], v[20:23], v[28:31], v[68:71]
    s_waitcnt vmcnt(8)
    v_perm_b32 v8, v140, v136, s58
    v_perm_b32 v9, v148, v144, s58
    v_perm_b32 v10, v156, v152, s58
    v_perm_b32 v11, v164, v160, s58
    v_perm_b32 v12, v140, v136, s59
    v_perm_b32 v13, v148, v144, s59
    v_perm_b32 v14, v156, v152, s59
    v_perm_b32 v15, v164, v160, s59
    v_perm_b32 v16, v141, v137, s58
    v_perm_b32 v17, v149, v145, s58
    v_perm_b32 v18, v157, v153, s58
    v_perm_b32 v19, v165, v161, s58
    v_perm_b32 v20, v141, v137, s59
    v_perm_b32 v21, v149, v145, s59
    v_perm_b32 v22, v157, v153, s59
    v_perm_b32 v23, v165, v161, s59
    s_nop 1
    v_mfma_f32_16x16x32_bf16 v[40:43], v[8:11], v[32:35], v[40:43]
    v_mfma_f32_16x16x32_bf16 v[44:47], v[12:15], v[32:35], v[44:47]
    v_mfma_f32_16x16x32_bf16 v[48:51], v[16:19], v[32:35], v[48:51]
    v_mfma_f32_16x16x32_bf16 v[52:55], v[20:23], v[32:35], v[52:55]
    v_perm_b32 v8, v142, v138, s58
    v_perm_b32 v9, v150, v146, s58
    v_perm_b32 v10, v158, v154, s58
    v_perm_b32 v11, v166, v162, s58
    v_perm_b32 v12, v142, v138, s59
    v_perm_b32 v13, v150, v146, s59
    v_perm_b32 v14, v158, v154, s59
    v_perm_b32 v15, v166, v162, s59
    v_perm_b32 v16, v143, v139, s58
    v_perm_b32 v17, v151, v147, s58
    v_perm_b32 v18, v159, v155, s58
    v_perm_b32 v19, v167, v163, s58
    v_perm_b32 v20, v143, v139, s59
    v_perm_b32 v21, v151, v147, s59
    v_perm_b32 v22, v159, v155, s59
    v_perm_b32 v23, v167, v163, s59
    s_nop 1
    v_mfma_f32_16x16x32_bf16 v[56:59], v[8:11], v[32:35], v[56:59]
    v_mfma_f32_16x16x32_bf16 v[60:63], v[12:15], v[32:35], v[60:63]
    v_mfma_f32_16x16x32_bf16 v[64:67], v[16:19], v[32:35], v[64:67]
    v_mfma_f32_16x16x32_bf16 v[68:71], v[20:23], v[32:35], v[68:71]
    s_waitcnt vmcnt(0)
    v_perm_b32 v8, v76, v72, s58
    v_perm_b32 v9, v84, v80, s58
    v_perm_b32 v10, v92, v88, s58
    v_perm_b32 v11, v100, v96, s58
    v_perm_b32 v12, v76, v72, s59
    v_perm_b32 v13, v84, v80, s59
    v_perm_b32 v14, v92, v88, s59
    v_perm_b32 v15, v100, v96, s59
    v_perm_b32 v16, v77, v73, s58
    v_perm_b32 v17, v85, v81, s58
    v_perm_b32 v18, v93, v89, s58
    v_perm_b32 v19, v101, v97, s58
    v_perm_b32 v20, v77, v73, s59
    v_perm_b32 v21, v85, v81, s59
    v_perm_b32 v22, v93, v89, s59
    v_perm_b32 v23, v101, v97, s59
    s_nop 1
    v_mfma_f32_16x16x32_bf16 v[40:43], v[8:11], v[36:39], v[40:43]
    v_mfma_f32_16x16x32_bf16 v[44:47], v[12:15], v[36:39], v[44:47]
    v_mfma_f32_16x16x32_bf16 v[48:51], v[16:19], v[36:39], v[48:51]
    v_mfma_f32_16x16x32_bf16 v[52:55], v[20:23], v[36:39], v[52:55]
    v_perm_b32 v8, v78, v74, s58
    v_perm_b32 v9, v86, v82, s58
    v_perm_b32 v10, v94, v90, s58
    v_perm_b32 v11, v102, v98, s58
    v_perm_b32 v12, v78, v74, s59
    v_perm_b32 v13, v86, v82, s59
    v_perm_b32 v14, v94, v90, s59
    v_perm_b32 v15, v102, v98, s59
    v_perm_b32 v16, v79, v75, s58
    v_perm_b32 v17, v87, v83, s58
    v_perm_b32 v18, v95, v91, s58
    v_perm_b32 v19, v103, v99, s58
    v_perm_b32 v20, v79, v75, s59
    v_perm_b32 v21, v87, v83, s59
    v_perm_b32 v22, v95, v91, s59
    v_perm_b32 v23, v103, v99, s59
    s_nop 1
    v_mfma_f32_16x16x32_bf16 v[56:59], v[8:11], v[36:39], v[56:59]
    v_mfma_f32_16x16x32_bf16 v[60:63], v[12:15], v[36:39], v[60:63]
    v_mfma_f32_16x16x32_bf16 v[64:67], v[16:19], v[36:39], v[64:67]
    v_mfma_f32_16x16x32_bf16 v[68:71], v[20:23], v[36:39], v[68:71]
    v_mov_b32 v6, 6744
    s_mov_b32 s51, 4000000
LW_42:
    ds_read_b32 v7, v6
    s_waitcnt lgkmcnt(0)
    v_readfirstlane_b32 s50, v7
    s_cmp_ge_u32 s50, 1
    s_cbranch_scc1 LWD_43
    s_sleep 1
    s_sub_u32 s51, s51, 1
    s_cmp_lg_u32 s51, 0
    s_cbranch_scc1 LW_42
LWD_43:
    s_mov_b32 s55, s50
    v_mov_b32 v6, 0
    s_mov_b32 s51, 40000
    s_mov_b64 exec, 1
CW_44:
    buffer_load_dword v7, v6, s[40:43], 0 offen sc1
    s_waitcnt vmcnt(0)
    v_readfirstlane_b32 s50, v7
    s_cmp_ge_u32 s50, 1
    s_cbranch_scc1 CWD_45
    s_sleep 8
    s_sub_u32 s51, s51, 1
    s_cmp_lg_u32 s51, 0
    s_cbranch_scc1 CW_44
CWD_45:
    s_mov_b64 exec, -1
    s_mov_b32 s55, s50
    v_lshlrev_b32 v3, 7, v0
    v_lshlrev_b32 v6, 6, v0
    v_lshrrev_b32 v6, 0, v6
    s_nop 0
    s_mov_b32 s46, 2883712
    s_mov_b32 s51, 40000
    s_mov_b64 exec, 15
F4_46:
    buffer_load_dword v9, v3, s[36:39], s46 offen sc1
    buffer_load_dword v7, v6, s[40:43], 0 offen sc1
    s_waitcnt vmcnt(0)
    v_cmp_ne_u32 vcc, v9, v7
    v_cmp_eq_u32 s[52:53], 0, v7
    s_or_b64 vcc, vcc, s[52:53]
    s_cbranch_vccz F4D_47
    s_sleep 16
    s_sub_u32 s51, s51, 1
    s_cmp_lg_u32 s51, 0
    s_cbranch_scc1 F4_46
F4D_47:
    s_mov_b64 exec, -1
    s_lshl_b32 s46, s3, 10
    s_lshl_b32 s47, s2, 11
    s_add_u32 s46, s46, s47
    s_add_u32 s46, s46, 261120
    s_nop 7
    s_nop 1
    v_cndmask_b32 v40, v40, v44, s[80:81]
    v_cndmask_b32 v41, v41, v45, s[80:81]
    v_cndmask_b32 v42, v42, v46, s[80:81]
    v_cndmask_b32 v43, v43, v47, s[80:81]
    v_cndmask_b32 v48, v48, v52, s[80:81]
    v_cndmask_b32 v49, v49, v53, s[80:81]
    v_cndmask_b32 v50, v50, v54, s[80:81]
    v_cndmask_b32 v51, v51, v55, s[80:81]
    v_cndmask_b32 v56, v56, v60, s[80:81]
    v_cndmask_b32 v57, v57, v61, s[80:81]
    v_cndmask_b32 v58, v58, v62, s[80:81]
    v_cndmask_b32 v59, v59, v63, s[80:81]
    v_cndmask_b32 v64, v64, v68, s[80:81]
    v_cndmask_b32 v65, v65, v69, s[80:81]
    v_cndmask_b32 v66, v66, v70, s[80:81]
    v_cndmask_b32 v67, v67, v71, s[80:81]
    v_cndmask_b32 v40, v40, v48, s[82:83]
    v_cndmask_b32 v41, v41, v49, s[82:83]
    v_cndmask_b32 v42, v42, v50, s[82:83]
    v_cndmask_b32 v43, v43, v51, s[82:83]
    v_cndmask_b32 v56, v56, v64, s[82:83]
    v_cndmask_b32 v57, v57, v65, s[82:83]
    v_cndmask_b32 v58, v58, v66, s[82:83]
    v_cndmask_b32 v59, v59, v67, s[82:83]
    v_cndmask_b32 v40, v40, v56, s[84:85]
    v_cndmask_b32 v41, v41, v57, s[84:85]
    v_cndmask_b32 v42, v42, v58, s[84:85]
    v_cndmask_b32 v43, v43, v59, s[84:85]
    v_perm_b32 v40, v40, v43, s90
    v_perm_b32 v41, v41, v43, s91
    v_perm_b32 v42, v42, v43, s92
    v_mov_b32 v43, s55
    buffer_store_dwordx4 v[40:43], v2, s[36:39], s46 offen sc1
    s_lshr_b32 s48, s2, 3
    s_add_u32 s48, s48, 16
    s_lshl_b32 s46, s48, 7
    s_add_u32 s46, s46, 3014656
    v_mov_b32 v6, s46
    v_mov_b32 v7, 1
    s_nop 0
    s_mov_b64 exec, 1
    buffer_atomic_add v7, v6, s[36:39], 0 offen sc0
    s_waitcnt vmcnt(0)
    v_readfirstlane_b32 s46, v7
    s_cmp_eq_u32 s46, 15
    s_cbranch_scc0 ARR_48
    s_lshl_b32 s46, s48, 7
    s_add_u32 s46, s46, 2883584
    v_mov_b32 v6, 0
    v_mov_b32 v7, s55
    buffer_store_dword v7, v6, s[36:39], s46 offen sc1
ARR_48:
    s_mov_b64 exec, -1
    s_branch L_A12_WO
L_A12_SKIP:
    s_barrier
    v_mov_b32 v6, 6748
    s_mov_b32 s51, 4000000
LW_49:
    ds_read_b32 v7, v6
    s_waitcnt lgkmcnt(0)
    v_readfirstlane_b32 s50, v7
    s_cmp_ge_u32 s50, 4
    s_cbranch_scc1 LWD_50
    s_sleep 1
    s_sub_u32 s51, s51, 1
    s_cmp_lg_u32 s51, 0
    s_cbranch_scc1 LW_49
LWD_50:
    v_mov_b32 v6, 6744
    s_mov_b32 s51, 4000000
LW_51:
    ds_read_b32 v7, v6
    s_waitcnt lgkmcnt(0)
    v_readfirstlane_b32 s50, v7
    s_cmp_ge_u32 s50, 1
    s_cbranch_scc1 LWD_52
    s_sleep 1
    s_sub_u32 s51, s51, 1
    s_cmp_lg_u32 s51, 0
    s_cbranch_scc1 LW_51
LWD_52:
    s_mov_b32 s55, s50
L_A12_WO:
    s_mov_b32 s28, s12
    s_mov_b32 s29, s13
    s_mov_b32 s30, 8388608
    s_mov_b32 s31, 0x20000
    s_and_b32 s44, s88, 3
    s_lshl_b32 s44, s44, 1
    s_add_u32 s44, s44, s3
    s_sub_u32 s44, s44, 1
    s_lshr_b32 s45, s88, 2
    s_lshl_b32 s45, s45, 17
    s_lshl_b32 s48, s44, 8
    s_add_u32 s45, s45, s48
    v_lshlrev_b32 v1, 14, v4
    v_lshl_add_u32 v1, v5, 4, v1
    v_mov_b32 v6, 6756
    s_mov_b32 s51, 4000000
LW_53:
    ds_read_b32 v7, v6
    s_waitcnt lgkmcnt(0)
    v_readfirstlane_b32 s50, v7
    s_cmp_ge_u32 s50, 4
    s_cbranch_scc1 LWD_54
    s_sleep 1
    s_sub_u32 s51, s51, 1
    s_cmp_lg_u32 s51, 0
    s_cbranch_scc1 LW_53
LWD_54:
    s_add_u32 s48, s45, 0
    buffer_load_dwordx4 v[72:75], v1, s[28:31], s48 offen nt
    s_add_u32 s48, s45, 2048
    buffer_load_dwordx4 v[76:79], v1, s[28:31], s48 offen nt
    s_add_u32 s48, s45, 4096
    buffer_load_dwordx4 v[80:83], v1, s[28:31], s48 offen nt
    s_add_u32 s48, s45, 6144
    buffer_load_dwordx4 v[84:87], v1, s[28:31], s48 offen nt
    s_add_u32 s48, s45, 8192
    buffer_load_dwordx4 v[88:91], v1, s[28:31], s48 offen nt
    s_add_u32 s48, s45, 10240
    buffer_load_dwordx4 v[92:95], v1, s[28:31], s48 offen nt
    s_add_u32 s48, s45, 12288
    buffer_load_dwordx4 v[96:99], v1, s[28:31], s48 offen nt
    s_add_u32 s48, s45, 14336
    buffer_load_dwordx4 v[100:103], v1, s[28:31], s48 offen nt
    s_add_u32 s48, s45, 65536
    buffer_load_dwordx4 v[104:107], v1, s[28:31], s48 offen nt
    s_add_u32 s48, s45, 67584
    buffer_load_dwordx4 v[108:111], v1, s[28:31], s48 offen nt
    s_add_u32 s48, s45, 69632
    buffer_load_dwordx4 v[112:115], v1, s[28:31], s48 offen nt
    s_add_u32 s48, s45, 71680
    buffer_load_dwordx4 v[116:119], v1, s[28:31], s48 offen nt
    s_add_u32 s48, s45, 73728
    buffer_load_dwordx4 v[120:123], v1, s[28:31], s48 offen nt
    s_add_u32 s48, s45, 75776
    buffer_load_dwordx4 v[124:127], v1, s[28:31], s48 offen nt
    s_add_u32 s48, s45, 77824
    buffer_load_dwordx4 v[128:131], v1, s[28:31], s48 offen nt
    s_add_u32 s48, s45, 79872
    buffer_load_dwordx4 v[132:135], v1, s[28:31], s48 offen nt
    s_waitcnt vmcnt(8)
    v_perm_b32 v136, v76, v72, s58
    v_perm_b32 v137, v84, v80, s58
    v_perm_b32 v138, v92, v88, s58
    v_perm_b32 v139, v100, v96, s58
    v_perm_b32 v140, v76, v72, s59
    v_perm_b32 v141, v84, v80, s59
    v_perm_b32 v142, v92, v88, s59
    v_perm_b32 v143, v100, v96, s59
    v_perm_b32 v144, v77, v73, s58
    v_perm_b32 v145, v85, v81, s58
    v_perm_b32 v146, v93, v89, s58
    v_perm_b32 v147, v101, v97, s58
    v_perm_b32 v148, v77, v73, s59
    v_perm_b32 v149, v85, v81, s59
    v_perm_b32 v150, v93, v89, s59
    v_perm_b32 v151, v101, v97, s59
    v_perm_b32 v152, v78, v74, s58
    v_perm_b32 v153, v86, v82, s58
    v_perm_b32 v154, v94, v90, s58
    v_perm_b32 v155, v102, v98, s58
    v_perm_b32 v156, v78, v74, s59
    v_perm_b32 v157, v86, v82, s59
    v_perm_b32 v158, v94, v90, s59
    v_perm_b32 v159, v102, v98, s59
    v_perm_b32 v160, v79, v75, s58
    v_perm_b32 v161, v87, v83, s58
    v_perm_b32 v162, v95, v91, s58
    v_perm_b32 v163, v103, v99, s58
    v_perm_b32 v164, v79, v75, s59
    v_perm_b32 v165, v87, v83, s59
    v_perm_b32 v166, v95, v91, s59
    v_perm_b32 v167, v103, v99, s59
    s_waitcnt vmcnt(0)
    v_perm_b32 v8, v108, v104, s58
    v_perm_b32 v9, v116, v112, s58
    v_perm_b32 v10, v124, v120, s58
    v_perm_b32 v11, v132, v128, s58
    v_perm_b32 v12, v108, v104, s59
    v_perm_b32 v13, v116, v112, s59
    v_perm_b32 v14, v124, v120, s59
    v_perm_b32 v15, v132, v128, s59
    v_perm_b32 v16, v109, v105, s58
    v_perm_b32 v17, v117, v113, s58
    v_perm_b32 v18, v125, v121, s58
    v_perm_b32 v19, v133, v129, s58
    v_perm_b32 v20, v109, v105, s59
    v_perm_b32 v21, v117, v113, s59
    v_perm_b32 v22, v125, v121, s59
    v_perm_b32 v23, v133, v129, s59
    v_perm_b32 v24, v110, v106, s58
    v_perm_b32 v25, v118, v114, s58
    v_perm_b32 v26, v126, v122, s58
    v_perm_b32 v27, v134, v130, s58
    v_perm_b32 v28, v110, v106, s59
    v_perm_b32 v29, v118, v114, s59
    v_perm_b32 v30, v126, v122, s59
    v_perm_b32 v31, v134, v130, s59
    v_perm_b32 v32, v111, v107, s58
    v_perm_b32 v33, v119, v115, s58
    v_perm_b32 v34, v127, v123, s58
    v_perm_b32 v35, v135, v131, s58
    v_perm_b32 v36, v111, v107, s59
    v_perm_b32 v37, v119, v115, s59
    v_perm_b32 v38, v127, v123, s59
    v_perm_b32 v39, v135, v131, s59
    v_and_b32 v3, 1, v0
    v_lshlrev_b32 v3, 7, v3
    v_lshl_add_u32 v3, v4, 4, v3
    v_add_u32 v3, 6912, v3
    s_lshl_b32 s46, s44, 16
    s_lshr_b32 s48, s88, 2
    s_lshl_b32 s48, s48, 9
    s_add_u32 s46, s46, s48
    s_add_u32 s46, s46, 786432
    v_and_b32 v2, 1, v0
    v_lshlrev_b32 v2, 15, v2
    v_lshl_add_u32 v2, v4, 7, v2
    v_bfe_u32 v6, v0, 1, 3
    v_lshl_add_u32 v2, v6, 4, v2
    v_mov_b32 v6, 6736
    s_mov_b32 s51, 4000000
LW_55:
    ds_read_b32 v7, v6
    s_waitcnt lgkmcnt(0)
    v_readfirstlane_b32 s50, v7
    s_cmp_ge_u32 s50, 1
    s_cbranch_scc1 LWD_56
    s_sleep 1
    s_sub_u32 s51, s51, 1
    s_cmp_lg_u32 s51, 0
    s_cbranch_scc1 LW_55
LWD_56:
    ds_read_b128 v[72:75], v3
    ds_read_b128 v[76:79], v3 offset:64
    s_waitcnt lgkmcnt(0)
    v_mfma_f32_16x16x32_bf16 v[40:43], v[136:139], v[72:75], 0
    v_mfma_f32_16x16x32_bf16 v[44:47], v[140:143], v[72:75], 0
    v_mfma_f32_16x16x32_bf16 v[48:51], v[144:147], v[72:75], 0
    v_mfma_f32_16x16x32_bf16 v[52:55], v[148:151], v[72:75], 0
    v_mfma_f32_16x16x32_bf16 v[56:59], v[152:155], v[72:75], 0
    v_mfma_f32_16x16x32_bf16 v[60:63], v[156:159], v[72:75], 0
    v_mfma_f32_16x16x32_bf16 v[64:67], v[160:163], v[72:75], 0
    v_mfma_f32_16x16x32_bf16 v[68:71], v[164:167], v[72:75], 0
    v_mfma_f32_16x16x32_bf16 v[40:43], v[8:11], v[76:79], v[40:43]
    v_mfma_f32_16x16x32_bf16 v[44:47], v[12:15], v[76:79], v[44:47]
    v_mfma_f32_16x16x32_bf16 v[48:51], v[16:19], v[76:79], v[48:51]
    v_mfma_f32_16x16x32_bf16 v[52:55], v[20:23], v[76:79], v[52:55]
    v_mfma_f32_16x16x32_bf16 v[56:59], v[24:27], v[76:79], v[56:59]
    v_mfma_f32_16x16x32_bf16 v[60:63], v[28:31], v[76:79], v[60:63]
    v_mfma_f32_16x16x32_bf16 v[64:67], v[32:35], v[76:79], v[64:67]
    v_mfma_f32_16x16x32_bf16 v[68:71], v[36:39], v[76:79], v[68:71]
    s_nop 7
    s_nop 1
    v_cndmask_b32 v40, v40, v44, s[80:81]
    v_cndmask_b32 v41, v41, v45, s[80:81]
    v_cndmask_b32 v42, v42, v46, s[80:81]
    v_cndmask_b32 v43, v43, v47, s[80:81]
    v_cndmask_b32 v48, v48, v52, s[80:81]
    v_cndmask_b32 v49, v49, v53, s[80:81]
    v_cndmask_b32 v50, v50, v54, s[80:81]
    v_cndmask_b32 v51, v51, v55, s[80:81]
    v_cndmask_b32 v56, v56, v60, s[80:81]
    v_cndmask_b32 v57, v57, v61, s[80:81]
    v_cndmask_b32 v58, v58, v62, s[80:81]
    v_cndmask_b32 v59, v59, v63, s[80:81]
    v_cndmask_b32 v64, v64, v68, s[80:81]
    v_cndmask_b32 v65, v65, v69, s[80:81]
    v_cndmask_b32 v66, v66, v70, s[80:81]
    v_cndmask_b32 v67, v67, v71, s[80:81]
    v_cndmask_b32 v40, v40, v48, s[82:83]
    v_cndmask_b32 v41, v41, v49, s[82:83]
    v_cndmask_b32 v42, v42, v50, s[82:83]
    v_cndmask_b32 v43, v43, v51, s[82:83]
    v_cndmask_b32 v56, v56, v64, s[82:83]
    v_cndmask_b32 v57, v57, v65, s[82:83]
    v_cndmask_b32 v58, v58, v66, s[82:83]
    v_cndmask_b32 v59, v59, v67, s[82:83]
    v_cndmask_b32 v40, v40, v56, s[84:85]
    v_cndmask_b32 v41, v41, v57, s[84:85]
    v_cndmask_b32 v42, v42, v58, s[84:85]
    v_cndmask_b32 v43, v43, v59, s[84:85]
    buffer_store_dwordx4 v[40:43], v2, s[36:39], s46 offen sc1
    s_waitcnt lgkmcnt(0)
    v_mov_b32 v6, 6760
    v_mov_b32 v7, 1
    s_mov_b64 exec, 1
    ds_add_u32 v6, v7
    s_mov_b64 exec, -1
    s_endpgm
L_BULK:
    s_mov_b32 s28, s6
    s_mov_b32 s29, s7
    s_mov_b32 s30, 67108864
    s_mov_b32 s31, 0x20000
    s_mov_b32 s32, s8
    s_mov_b32 s33, s9
    s_mov_b32 s34, 67108864
    s_mov_b32 s35, 0x20000
    s_sub_u32 s44, s3, 4
    s_lshr_b32 s45, s86, 6
    s_bfe_u32 s46, s86, 0x10005
    s_lshl_b32 s46, s46, 2
    s_add_u32 s45, s45, s46
    s_lshl_b32 s45, s45, 23
    s_mov_b32 s4, s45
    s_and_b32 s46, s86, 31
    s_lshl_b32 s46, s46, 18
    s_add_u32 s45, s45, s46
    s_lshl_b32 s46, s44, 13
    s_add_u32 s45, s45, s46
    v_and_b32 v4, 15, v0
    v_lshrrev_b32 v5, 4, v0
    v_lshlrev_b32 v2, 4, v0
    s_lshl_b32 s48, s44, 15
    s_add_u32 s48, s48, 24576
    v_xor_b32 v6, v4, v5
    v_lshlrev_b32 v7, 8, v5
    v_lshl_add_u32 v240, v6, 4, v7
    v_xor_b32 v241, 64, v240
    v_add_u32 v241, 1024, v241
    v_xor_b32 v242, 128, v240
    v_add_u32 v242, 2048, v242
    v_xor_b32 v243, 192, v240
    v_add_u32 v243, 3072, v243
    v_and_b32 v6, 3, v4
    v_lshlrev_b32 v6, 2, v6
    v_lshrrev_b32 v7, 2, v4
    v_add_u32 v6, v6, v7
    v_xor_b32 v7, v6, v5
    v_lshlrev_b32 v6, 8, v6
    v_lshl_add_u32 v244, v7, 4, v6
    v_xor_b32 v245, 64, v244
    v_xor_b32 v246, 128, v244
    v_xor_b32 v247, 192, v244
    v_add_u32 v244, s48, v244
    v_add_u32 v245, s48, v245
    v_add_u32 v246, s48, v246
    v_add_u32 v247, s48, v247
    s_barrier
    s_add_u32 s5, s45, 0
    s_waitcnt vmcnt(12)
    s_add_u32 s46, s5, 0
    s_add_u32 s49, s48, 0
    s_mov_b32 m0, s49
    s_nop 0
    buffer_load_dwordx4 v240, s[28:31], s46 offen nt lds
    s_add_u32 s49, s48, 1024
    s_mov_b32 m0, s49
    s_nop 0
    buffer_load_dwordx4 v241, s[28:31], s46 offen nt lds
    s_add_u32 s49, s48, 2048
    s_mov_b32 m0, s49
    s_nop 0
    buffer_load_dwordx4 v242, s[28:31], s46 offen nt lds
    s_add_u32 s49, s48, 3072
    s_mov_b32 m0, s49
    s_nop 0
    buffer_load_dwordx4 v243, s[28:31], s46 offen nt lds
    s_waitcnt vmcnt(12)
    s_add_u32 s46, s5, 4096
    s_add_u32 s49, s48, 4096
    s_mov_b32 m0, s49
    s_nop 0
    buffer_load_dwordx4 v240, s[28:31], s46 offen nt lds
    s_add_u32 s49, s48, 5120
    s_mov_b32 m0, s49
    s_nop 0
    buffer_load_dwordx4 v241, s[28:31], s46 offen nt lds
    s_add_u32 s49, s48, 6144
    s_mov_b32 m0, s49
    s_nop 0
    buffer_load_dwordx4 v242, s[28:31], s46 offen nt lds
    s_add_u32 s49, s48, 7168
    s_mov_b32 m0, s49
    s_nop 0
    buffer_load_dwordx4 v243, s[28:31], s46 offen nt lds
    s_waitcnt vmcnt(12)
    s_add_u32 s46, s5, 0
    buffer_load_dwordx4 v[112:115], v2, s[32:35], s46 offen offset:0 nt
    buffer_load_dwordx4 v[116:119], v2, s[32:35], s46 offen offset:1024 nt
    buffer_load_dwordx4 v[120:123], v2, s[32:35], s46 offen offset:2048 nt
    buffer_load_dwordx4 v[124:127], v2, s[32:35], s46 offen offset:3072 nt
    s_waitcnt vmcnt(12)
    v_mov_b32 v6, 6752
    s_mov_b32 s51, 4000000
LW_57:
    ds_read_b32 v7, v6
    s_waitcnt lgkmcnt(0)
    v_readfirstlane_b32 s50, v7
    s_cmp_ge_u32 s50, 1
    s_cbranch_scc1 LWD_58
    s_sleep 1
    s_sub_u32 s51, s51, 1
    s_cmp_lg_u32 s51, 0
    s_cbranch_scc1 LW_57
LWD_58:
    s_add_u32 s46, s5, 4096
    buffer_load_dwordx4 v[128:131], v2, s[32:35], s46 offen offset:0 nt
    buffer_load_dwordx4 v[132:135], v2, s[32:35], s46 offen offset:1024 nt
    buffer_load_dwordx4 v[136:139], v2, s[32:35], s46 offen offset:2048 nt
    buffer_load_dwordx4 v[140:143], v2, s[32:35], s46 offen offset:3072 nt
    s_add_u32 s5, s45, 32768
    s_waitcnt vmcnt(12)
    s_add_u32 s46, s5, 0
    s_add_u32 s49, s48, 8192
    s_mov_b32 m0, s49
    s_nop 0
    buffer_load_dwordx4 v240, s[28:31], s46 offen nt lds
    s_add_u32 s49, s48, 9216
    s_mov_b32 m0, s49
    s_nop 0
    buffer_load_dwordx4 v241, s[28:31], s46 offen nt lds
    s_add_u32 s49, s48, 10240
    s_mov_b32 m0, s49
    s_nop 0
    buffer_load_dwordx4 v242, s[28:31], s46 offen nt lds
    s_add_u32 s49, s48, 11264
    s_mov_b32 m0, s49
    s_nop 0
    buffer_load_dwordx4 v243, s[28:31], s46 offen nt lds
    s_waitcnt vmcnt(12)
    s_add_u32 s46, s5, 4096
    s_add_u32 s49, s48, 12288
    s_mov_b32 m0, s49
    s_nop 0
    buffer_load_dwordx4 v240, s[28:31], s46 offen nt lds
    s_add_u32 s49, s48, 13312
    s_mov_b32 m0, s49
    s_nop 0
    buffer_load_dwordx4 v241, s[28:31], s46 offen nt lds
    s_add_u32 s49, s48, 14336
    s_mov_b32 m0, s49
    s_nop 0
    buffer_load_dwordx4 v242, s[28:31], s46 offen nt lds
    s_add_u32 s49, s48, 15360
    s_mov_b32 m0, s49
    s_nop 0
    buffer_load_dwordx4 v243, s[28:31], s46 offen nt lds
    s_waitcnt vmcnt(12)
    s_add_u32 s46, s5, 0
    buffer_load_dwordx4 v[144:147], v2, s[32:35], s46 offen offset:0 nt
    buffer_load_dwordx4 v[148:151], v2, s[32:35], s46 offen offset:1024 nt
    buffer_load_dwordx4 v[152:155], v2, s[32:35], s46 offen offset:2048 nt
    buffer_load_dwordx4 v[156:159], v2, s[32:35], s46 offen offset:3072 nt
    s_waitcnt vmcnt(12)
    s_add_u32 s46, s5, 4096
    buffer_load_dwordx4 v[160:163], v2, s[32:35], s46 offen offset:0 nt
    buffer_load_dwordx4 v[164:167], v2, s[32:35], s46 offen offset:1024 nt
    buffer_load_dwordx4 v[168:171], v2, s[32:35], s46 offen offset:2048 nt
    buffer_load_dwordx4 v[172:175], v2, s[32:35], s46 offen offset:3072 nt
    s_add_u32 s5, s45, 65536
    s_waitcnt vmcnt(12)
    s_add_u32 s46, s5, 0
    s_add_u32 s49, s48, 16384
    s_mov_b32 m0, s49
    s_nop 0
    buffer_load_dwordx4 v240, s[28:31], s46 offen nt lds
    s_add_u32 s49, s48, 17408
    s_mov_b32 m0, s49
    s_nop 0
    buffer_load_dwordx4 v241, s[28:31], s46 offen nt lds
    s_add_u32 s49, s48, 18432
    s_mov_b32 m0, s49
    s_nop 0
    buffer_load_dwordx4 v242, s[28:31], s46 offen nt lds
    s_add_u32 s49, s48, 19456
    s_mov_b32 m0, s49
    s_nop 0
    buffer_load_dwordx4 v243, s[28:31], s46 offen nt lds
    s_waitcnt vmcnt(12)
    s_add_u32 s46, s5, 4096
    s_add_u32 s49, s48, 20480
    s_mov_b32 m0, s49
    s_nop 0
    buffer_load_dwordx4 v240, s[28:31], s46 offen nt lds
    s_add_u32 s49, s48, 21504
    s_mov_b32 m0, s49
    s_nop 0
    buffer_load_dwordx4 v241, s[28:31], s46 offen nt lds
    s_add_u32 s49, s48, 22528
    s_mov_b32 m0, s49
    s_nop 0
    buffer_load_dwordx4 v242, s[28:31], s46 offen nt lds
    s_add_u32 s49, s48, 23552
    s_mov_b32 m0, s49
    s_nop 0
    buffer_load_dwordx4 v243, s[28:31], s46 offen nt lds
    s_waitcnt vmcnt(12)
    s_add_u32 s46, s5, 0
    buffer_load_dwordx4 v[176:179], v2, s[32:35], s46 offen offset:0 nt
    buffer_load_dwordx4 v[180:183], v2, s[32:35], s46 offen offset:1024 nt
    buffer_load_dwordx4 v[184:187], v2, s[32:35], s46 offen offset:2048 nt
    buffer_load_dwordx4 v[188:191], v2, s[32:35], s46 offen offset:3072 nt
    s_waitcnt vmcnt(12)
    s_add_u32 s46, s5, 4096
    buffer_load_dwordx4 v[192:195], v2, s[32:35], s46 offen offset:0 nt
    buffer_load_dwordx4 v[196:199], v2, s[32:35], s46 offen offset:1024 nt
    buffer_load_dwordx4 v[200:203], v2, s[32:35], s46 offen offset:2048 nt
    buffer_load_dwordx4 v[204:207], v2, s[32:35], s46 offen offset:3072 nt
    s_add_u32 s5, s45, 98304
    s_waitcnt vmcnt(12)
    s_waitcnt lgkmcnt(0)
    v_mov_b32 v6, 6748
    v_mov_b32 v7, 1
    s_mov_b64 exec, 1
    ds_add_u32 v6, v7
    s_mov_b64 exec, -1
    s_add_u32 s46, s5, 0
    s_add_u32 s49, s48, 24576
    s_mov_b32 m0, s49
    s_nop 0
    buffer_load_dwordx4 v240, s[28:31], s46 offen nt lds
    s_add_u32 s49, s48, 25600
    s_mov_b32 m0, s49
    s_nop 0
    buffer_load_dwordx4 v241, s[28:31], s46 offen nt lds
    s_add_u32 s49, s48, 26624
    s_mov_b32 m0, s49
    s_nop 0
    buffer_load_dwordx4 v242, s[28:31], s46 offen nt lds
    s_add_u32 s49, s48, 27648
    s_mov_b32 m0, s49
    s_nop 0
    buffer_load_dwordx4 v243, s[28:31], s46 offen nt lds
    s_waitcnt vmcnt(12)
    s_add_u32 s46, s5, 4096
    s_add_u32 s49, s48, 28672
    s_mov_b32 m0, s49
    s_nop 0
    buffer_load_dwordx4 v240, s[28:31], s46 offen nt lds
    s_add_u32 s49, s48, 29696
    s_mov_b32 m0, s49
    s_nop 0
    buffer_load_dwordx4 v241, s[28:31], s46 offen nt lds
    s_add_u32 s49, s48, 30720
    s_mov_b32 m0, s49
    s_nop 0
    buffer_load_dwordx4 v242, s[28:31], s46 offen nt lds
    s_add_u32 s49, s48, 31744
    s_mov_b32 m0, s49
    s_nop 0
    buffer_load_dwordx4 v243, s[28:31], s46 offen nt lds
    s_waitcnt vmcnt(12)
    s_add_u32 s46, s5, 0
    buffer_load_dwordx4 v[208:211], v2, s[32:35], s46 offen offset:0 nt
    buffer_load_dwordx4 v[212:215], v2, s[32:35], s46 offen offset:1024 nt
    buffer_load_dwordx4 v[216:219], v2, s[32:35], s46 offen offset:2048 nt
    buffer_load_dwordx4 v[220:223], v2, s[32:35], s46 offen offset:3072 nt
    s_waitcnt vmcnt(12)
    s_add_u32 s46, s5, 4096
    buffer_load_dwordx4 v[224:227], v2, s[32:35], s46 offen offset:0 nt
    buffer_load_dwordx4 v[228:231], v2, s[32:35], s46 offen offset:1024 nt
    buffer_load_dwordx4 v[232:235], v2, s[32:35], s46 offen offset:2048 nt
    buffer_load_dwordx4 v[236:239], v2, s[32:35], s46 offen offset:3072 nt
    s_andn2_b32 s46, s86, 31
    s_add_u32 s46, s46, 256
    s_lshl_b32 s46, s46, 7
    s_add_u32 s46, s46, 3014656
    v_mov_b32 v1, s46
    v_mov_b32 v248, 0xff800000
    v_mov_b32 v249, 0
    v_mov_b32 v48, 0
    v_mov_b32 v49, 0
    v_mov_b32 v50, 0
    v_mov_b32 v51, 0
    v_mov_b32 v52, 0
    v_mov_b32 v53, 0
    v_mov_b32 v54, 0
    v_mov_b32 v55, 0
    v_mov_b32 v56, 0
    v_mov_b32 v57, 0
    v_mov_b32 v58, 0
    v_mov_b32 v59, 0
    v_mov_b32 v60, 0
    v_mov_b32 v61, 0
    v_mov_b32 v62, 0
    v_mov_b32 v63, 0
    v_mov_b32 v64, 0
    v_mov_b32 v65, 0
    v_mov_b32 v66, 0
    v_mov_b32 v67, 0
    v_mov_b32 v68, 0
    v_mov_b32 v69, 0
    v_mov_b32 v70, 0
    v_mov_b32 v71, 0
    v_mov_b32 v72, 0
    v_mov_b32 v73, 0
    v_mov_b32 v74, 0
    v_mov_b32 v75, 0
    v_mov_b32 v76, 0
    v_mov_b32 v77, 0
    v_mov_b32 v78, 0
    v_mov_b32 v79, 0
    v_mov_b32 v6, 6720
    s_mov_b32 s51, 4000000
LW_59:
    ds_read_b32 v7, v6
    s_waitcnt lgkmcnt(0)
    v_readfirstlane_b32 s50, v7
    s_cmp_ge_u32 s50, 2
    s_cbranch_scc1 LWD_60
    s_sleep 1
    s_sub_u32 s51, s51, 1
    s_cmp_lg_u32 s51, 0
    s_cbranch_scc1 LW_59
LWD_60:
    v_and_b32 v3, 7, v0
    v_lshlrev_b32 v3, 8, v3
    v_lshl_add_u32 v3, v5, 4, v3
    ds_read_b128 v[8:11], v3 offset:4096
    ds_read_b128 v[12:15], v3 offset:4160
    ds_read_b128 v[16:19], v3 offset:4224
    ds_read_b128 v[20:23], v3 offset:4288
    s_waitcnt vmcnt(56)
    ds_read_b128 v[80:83], v244 offset:0
    ds_read_b128 v[84:87], v245 offset:0
    ds_read_b128 v[88:91], v246 offset:0
    ds_read_b128 v[92:95], v247 offset:0
    ds_read_b128 v[96:99], v244 offset:4096
    ds_read_b128 v[100:103], v245 offset:4096
    ds_read_b128 v[104:107], v246 offset:4096
    ds_read_b128 v[108:111], v247 offset:4096
    s_waitcnt lgkmcnt(4)
    v_mfma_f32_16x16x32_bf16 v[24:27], v[80:83], v[8:11], 0
    v_mfma_f32_16x16x32_bf16 v[24:27], v[84:87], v[12:15], v[24:27]
    v_mfma_f32_16x16x32_bf16 v[24:27], v[88:91], v[16:19], v[24:27]
    v_mfma_f32_16x16x32_bf16 v[24:27], v[92:95], v[20:23], v[24:27]
    s_waitcnt lgkmcnt(0)
    v_mfma_f32_16x16x32_bf16 v[28:31], v[96:99], v[8:11], 0
    v_mfma_f32_16x16x32_bf16 v[28:31], v[100:103], v[12:15], v[28:31]
    v_mfma_f32_16x16x32_bf16 v[28:31], v[104:107], v[16:19], v[28:31]
    v_mfma_f32_16x16x32_bf16 v[28:31], v[108:111], v[20:23], v[28:31]
    s_add_u32 s5, s45, 131072
    s_waitcnt vmcnt(12)
    s_add_u32 s46, s5, 0
    s_add_u32 s49, s48, 0
    s_mov_b32 m0, s49
    s_nop 0
    buffer_load_dwordx4 v240, s[28:31], s46 offen nt lds
    s_add_u32 s49, s48, 1024
    s_mov_b32 m0, s49
    s_nop 0
    buffer_load_dwordx4 v241, s[28:31], s46 offen nt lds
    s_add_u32 s49, s48, 2048
    s_mov_b32 m0, s49
    s_nop 0
    buffer_load_dwordx4 v242, s[28:31], s46 offen nt lds
    s_add_u32 s49, s48, 3072
    s_mov_b32 m0, s49
    s_nop 0
    buffer_load_dwordx4 v243, s[28:31], s46 offen nt lds
    s_waitcnt vmcnt(12)
    s_add_u32 s46, s5, 4096
    s_add_u32 s49, s48, 4096
    s_mov_b32 m0, s49
    s_nop 0
    buffer_load_dwordx4 v240, s[28:31], s46 offen nt lds
    s_add_u32 s49, s48, 5120
    s_mov_b32 m0, s49
    s_nop 0
    buffer_load_dwordx4 v241, s[28:31], s46 offen nt lds
    s_add_u32 s49, s48, 6144
    s_mov_b32 m0, s49
    s_nop 0
    buffer_load_dwordx4 v242, s[28:31], s46 offen nt lds
    s_add_u32 s49, s48, 7168
    s_mov_b32 m0, s49
    s_nop 0
    buffer_load_dwordx4 v243, s[28:31], s46 offen nt lds
    s_nop 7
    v_cvt_pk_bf16_f32 v250, v24, v25
    v_lshlrev_b32 v24, 16, v250
    v_and_b32 v25, 0xffff0000, v250
    v_mul_f32 v24, s61, v24
    v_mul_f32 v25, s61, v25
    v_cvt_pk_bf16_f32 v250, v24, v25
    v_lshlrev_b32 v24, 16, v250
    v_and_b32 v25, 0xffff0000, v250
    v_cvt_pk_bf16_f32 v250, v26, v27
    v_lshlrev_b32 v26, 16, v250
    v_and_b32 v27, 0xffff0000, v250
    v_mul_f32 v26, s61, v26
    v_mul_f32 v27, s61, v27
    v_cvt_pk_bf16_f32 v250, v26, v27
    v_lshlrev_b32 v26, 16, v250
    v_and_b32 v27, 0xffff0000, v250
    v_cvt_pk_bf16_f32 v250, v28, v29
    v_lshlrev_b32 v28, 16, v250
    v_and_b32 v29, 0xffff0000, v250
    v_mul_f32 v28, s61, v28
    v_mul_f32 v29, s61, v29
    v_cvt_pk_bf16_f32 v250, v28, v29
    v_lshlrev_b32 v28, 16, v250
    v_and_b32 v29, 0xffff0000, v250
    v_cvt_pk_bf16_f32 v250, v30, v31
    v_lshlrev_b32 v30, 16, v250
    v_and_b32 v31, 0xffff0000, v250
    v_mul_f32 v30, s61, v30
    v_mul_f32 v31, s61, v31
    v_cvt_pk_bf16_f32 v250, v30, v31
    v_lshlrev_b32 v30, 16, v250
    v_and_b32 v31, 0xffff0000, v250
    v_max3_f32 v250, v24, v25, v248
    v_max3_f32 v250, v250, v26, v27
    v_max3_f32 v250, v250, v28, v29
    v_max3_f32 v250, v250, v30, v31
    v_mov_b32 v251, v250
    s_nop 1
    v_permlane16_swap_b32 v250, v251
    s_nop 1
    v_max_f32 v250, v250, v251
    v_mov_b32 v251, v250
    s_nop 1
    v_permlane32_swap_b32 v250, v251
    s_nop 1
    v_max_f32 v250, v250, v251
    v_sub_f32 v252, v248, v250
    v_mul_f32 v252, s60, v252
    v_exp_f32 v252, v252
    v_mov_b32 v248, v250
    v_mov_b32 v253, 0
    v_mov_b32 v254, 0
    v_sub_f32 v24, v24, v248
    v_sub_f32 v25, v25, v248
    v_mul_f32 v24, s60, v24
    v_mul_f32 v25, s60, v25
    v_exp_f32 v24, v24
    v_exp_f32 v25, v25
    s_nop 0
    v_add_f32 v253, v253, v24
    v_add_f32 v254, v254, v25
    v_cvt_pk_bf16_f32 v40, v24, v25
    v_sub_f32 v26, v26, v248
    v_sub_f32 v27, v27, v248
    v_mul_f32 v26, s60, v26
    v_mul_f32 v27, s60, v27
    v_exp_f32 v26, v26
    v_exp_f32 v27, v27
    s_nop 0
    v_add_f32 v253, v253, v26
    v_add_f32 v254, v254, v27
    v_cvt_pk_bf16_f32 v41, v26, v27
    v_sub_f32 v28, v28, v248
    v_sub_f32 v29, v29, v248
    v_mul_f32 v28, s60, v28
    v_mul_f32 v29, s60, v29
    v_exp_f32 v28, v28
    v_exp_f32 v29, v29
    s_nop 0
    v_add_f32 v253, v253, v28
    v_add_f32 v254, v254, v29
    v_cvt_pk_bf16_f32 v42, v28, v29
    v_sub_f32 v30, v30, v248
    v_sub_f32 v31, v31, v248
    v_mul_f32 v30, s60, v30
    v_mul_f32 v31, s60, v31
    v_exp_f32 v30, v30
    v_exp_f32 v31, v31
    s_nop 0
    v_add_f32 v253, v253, v30
    v_add_f32 v254, v254, v31
    v_cvt_pk_bf16_f32 v43, v30, v31
    v_add_f32 v253, v253, v254
    v_fma_f32 v249, v249, v252, v253
    v_mul_f32 v48, v48, v252
    v_mul_f32 v49, v49, v252
    v_mul_f32 v50, v50, v252
    v_mul_f32 v51, v51, v252
    v_mul_f32 v52, v52, v252
    v_mul_f32 v53, v53, v252
    v_mul_f32 v54, v54, v252
    v_mul_f32 v55, v55, v252
    v_mul_f32 v56, v56, v252
    v_mul_f32 v57, v57, v252
    v_mul_f32 v58, v58, v252
    v_mul_f32 v59, v59, v252
    v_mul_f32 v60, v60, v252
    v_mul_f32 v61, v61, v252
    v_mul_f32 v62, v62, v252
    v_mul_f32 v63, v63, v252
    v_mul_f32 v64, v64, v252
    v_mul_f32 v65, v65, v252
    v_mul_f32 v66, v66, v252
    v_mul_f32 v67, v67, v252
    v_mul_f32 v68, v68, v252
    v_mul_f32 v69, v69, v252
    v_mul_f32 v70, v70, v252
    v_mul_f32 v71, v71, v252
    v_mul_f32 v72, v72, v252
    v_mul_f32 v73, v73, v252
    v_mul_f32 v74, v74, v252
    v_mul_f32 v75, v75, v252
    v_mul_f32 v76, v76, v252
    v_mul_f32 v77, v77, v252
    v_mul_f32 v78, v78, v252
    v_mul_f32 v79, v79, v252
    s_waitcnt vmcnt(56)
    v_perm_b32 v24, v116, v112, s58
    v_perm_b32 v25, v124, v120, s58
    v_perm_b32 v26, v132, v128, s58
    v_perm_b32 v27, v140, v136, s58
    v_perm_b32 v28, v116, v112, s59
    v_perm_b32 v29, v124, v120, s59
    v_perm_b32 v30, v132, v128, s59
    v_perm_b32 v31, v140, v136, s59
    v_perm_b32 v32, v117, v113, s58
    v_perm_b32 v33, v125, v121, s58
    v_perm_b32 v34, v133, v129, s58
    v_perm_b32 v35, v141, v137, s58
    v_perm_b32 v36, v117, v113, s59
    v_perm_b32 v37, v125, v121, s59
    v_perm_b32 v38, v133, v129, s59
    v_perm_b32 v39, v141, v137, s59
    s_nop 1
    v_mfma_f32_16x16x32_bf16 v[48:51], v[24:27], v[40:43], v[48:51]
    v_mfma_f32_16x16x32_bf16 v[52:55], v[28:31], v[40:43], v[52:55]
    v_mfma_f32_16x16x32_bf16 v[56:59], v[32:35], v[40:43], v[56:59]
    v_mfma_f32_16x16x32_bf16 v[60:63], v[36:39], v[40:43], v[60:63]
    v_perm_b32 v24, v118, v114, s58
    v_perm_b32 v25, v126, v122, s58
    v_perm_b32 v26, v134, v130, s58
    v_perm_b32 v27, v142, v138, s58
    v_perm_b32 v28, v118, v114, s59
    v_perm_b32 v29, v126, v122, s59
    v_perm_b32 v30, v134, v130, s59
    v_perm_b32 v31, v142, v138, s59
    v_perm_b32 v32, v119, v115, s58
    v_perm_b32 v33, v127, v123, s58
    v_perm_b32 v34, v135, v131, s58
    v_perm_b32 v35, v143, v139, s58
    v_perm_b32 v36, v119, v115, s59
    v_perm_b32 v37, v127, v123, s59
    v_perm_b32 v38, v135, v131, s59
    v_perm_b32 v39, v143, v139, s59
    s_nop 1
    v_mfma_f32_16x16x32_bf16 v[64:67], v[24:27], v[40:43], v[64:67]
    v_mfma_f32_16x16x32_bf16 v[68:71], v[28:31], v[40:43], v[68:71]
    v_mfma_f32_16x16x32_bf16 v[72:75], v[32:35], v[40:43], v[72:75]
    v_mfma_f32_16x16x32_bf16 v[76:79], v[36:39], v[40:43], v[76:79]
    s_nop 7
    s_waitcnt vmcnt(12)
    s_add_u32 s46, s5, 0
    buffer_load_dwordx4 v[112:115], v2, s[32:35], s46 offen offset:0 nt
    buffer_load_dwordx4 v[116:119], v2, s[32:35], s46 offen offset:1024 nt
    buffer_load_dwordx4 v[120:123], v2, s[32:35], s46 offen offset:2048 nt
    buffer_load_dwordx4 v[124:127], v2, s[32:35], s46 offen offset:3072 nt
    s_waitcnt vmcnt(12)
    s_add_u32 s46, s5, 4096
    buffer_load_dwordx4 v[128:131], v2, s[32:35], s46 offen offset:0 nt
    buffer_load_dwordx4 v[132:135], v2, s[32:35], s46 offen offset:1024 nt
    buffer_load_dwordx4 v[136:139], v2, s[32:35], s46 offen offset:2048 nt
    buffer_load_dwordx4 v[140:143], v2, s[32:35], s46 offen offset:3072 nt
    s_waitcnt vmcnt(56)
    ds_read_b128 v[80:83], v244 offset:8192
    ds_read_b128 v[84:87], v245 offset:8192
    ds_read_b128 v[88:91], v246 offset:8192
    ds_read_b128 v[92:95], v247 offset:8192
    ds_read_b128 v[96:99], v244 offset:12288
    ds_read_b128 v[100:103], v245 offset:12288
    ds_read_b128 v[104:107], v246 offset:12288
    ds_read_b128 v[108:111], v247 offset:12288
    s_waitcnt lgkmcnt(4)
    v_mfma_f32_16x16x32_bf16 v[24:27], v[80:83], v[8:11], 0
    v_mfma_f32_16x16x32_bf16 v[24:27], v[84:87], v[12:15], v[24:27]
    v_mfma_f32_16x16x32_bf16 v[24:27], v[88:91], v[16:19], v[24:27]
    v_mfma_f32_16x16x32_bf16 v[24:27], v[92:95], v[20:23], v[24:27]
    s_waitcnt lgkmcnt(0)
    v_mfma_f32_16x16x32_bf16 v[28:31], v[96:99], v[8:11], 0
    v_mfma_f32_16x16x32_bf16 v[28:31], v[100:103], v[12:15], v[28:31]
    v_mfma_f32_16x16x32_bf16 v[28:31], v[104:107], v[16:19], v[28:31]
    v_mfma_f32_16x16x32_bf16 v[28:31], v[108:111], v[20:23], v[28:31]
    s_add_u32 s5, s45, 163840
    v_mov_b32 v255, 1
    s_mov_b64 exec, 1
    buffer_atomic_add v255, v1, s[36:39], 0 offen sc0
    s_mov_b64 exec, -1
    s_waitcnt vmcnt(12)
    s_add_u32 s46, s5, 0
    s_add_u32 s49, s48, 8192
    s_mov_b32 m0, s49
    s_nop 0
    buffer_load_dwordx4 v240, s[28:31], s46 offen nt lds
    s_add_u32 s49, s48, 9216
    s_mov_b32 m0, s49
    s_nop 0
    buffer_load_dwordx4 v241, s[28:31], s46 offen nt lds
    s_add_u32 s49, s48, 10240
    s_mov_b32 m0, s49
    s_nop 0
    buffer_load_dwordx4 v242, s[28:31], s46 offen nt lds
    s_add_u32 s49, s48, 11264
    s_mov_b32 m0, s49
    s_nop 0
    buffer_load_dwordx4 v243, s[28:31], s46 offen nt lds
    s_waitcnt vmcnt(12)
    s_add_u32 s46, s5, 4096
    s_add_u32 s49, s48, 12288
    s_mov_b32 m0, s49
    s_nop 0
    buffer_load_dwordx4 v240, s[28:31], s46 offen nt lds
    s_add_u32 s49, s48, 13312
    s_mov_b32 m0, s49
    s_nop 0
    buffer_load_dwordx4 v241, s[28:31], s46 offen nt lds
    s_add_u32 s49, s48, 14336
    s_mov_b32 m0, s49
    s_nop 0
    buffer_load_dwordx4 v242, s[28:31], s46 offen nt lds
    s_add_u32 s49, s48, 15360
    s_mov_b32 m0, s49
    s_nop 0
    buffer_load_dwordx4 v243, s[28:31], s46 offen nt lds
    s_nop 7
    v_cvt_pk_bf16_f32 v250, v24, v25
    v_lshlrev_b32 v24, 16, v250
    v_and_b32 v25, 0xffff0000, v250
    v_mul_f32 v24, s61, v24
    v_mul_f32 v25, s61, v25
    v_cvt_pk_bf16_f32 v250, v24, v25
    v_lshlrev_b32 v24, 16, v250
    v_and_b32 v25, 0xffff0000, v250
    v_cvt_pk_bf16_f32 v250, v26, v27
    v_lshlrev_b32 v26, 16, v250
    v_and_b32 v27, 0xffff0000, v250
    v_mul_f32 v26, s61, v26
    v_mul_f32 v27, s61, v27
    v_cvt_pk_bf16_f32 v250, v26, v27
    v_lshlrev_b32 v26, 16, v250
    v_and_b32 v27, 0xffff0000, v250
    v_cvt_pk_bf16_f32 v250, v28, v29
    v_lshlrev_b32 v28, 16, v250
    v_and_b32 v29, 0xffff0000, v250
    v_mul_f32 v28, s61, v28
    v_mul_f32 v29, s61, v29
    v_cvt_pk_bf16_f32 v250, v28, v29
    v_lshlrev_b32 v28, 16, v250
    v_and_b32 v29, 0xffff0000, v250
    v_cvt_pk_bf16_f32 v250, v30, v31
    v_lshlrev_b32 v30, 16, v250
    v_and_b32 v31, 0xffff0000, v250
    v_mul_f32 v30, s61, v30
    v_mul_f32 v31, s61, v31
    v_cvt_pk_bf16_f32 v250, v30, v31
    v_lshlrev_b32 v30, 16, v250
    v_and_b32 v31, 0xffff0000, v250
    v_max3_f32 v250, v24, v25, v248
    v_max3_f32 v250, v250, v26, v27
    v_max3_f32 v250, v250, v28, v29
    v_max3_f32 v250, v250, v30, v31
    v_mov_b32 v251, v250
    s_nop 1
    v_permlane16_swap_b32 v250, v251
    s_nop 1
    v_max_f32 v250, v250, v251
    v_mov_b32 v251, v250
    s_nop 1
    v_permlane32_swap_b32 v250, v251
    s_nop 1
    v_max_f32 v250, v250, v251
    v_sub_f32 v252, v248, v250
    v_mul_f32 v252, s60, v252
    v_exp_f32 v252, v252
    v_mov_b32 v248, v250
    v_mov_b32 v253, 0
    v_mov_b32 v254, 0
    v_sub_f32 v24, v24, v248
    v_sub_f32 v25, v25, v248
    v_mul_f32 v24, s60, v24
    v_mul_f32 v25, s60, v25
    v_exp_f32 v24, v24
    v_exp_f32 v25, v25
    s_nop 0
    v_add_f32 v253, v253, v24
    v_add_f32 v254, v254, v25
    v_cvt_pk_bf16_f32 v40, v24, v25
    v_sub_f32 v26, v26, v248
    v_sub_f32 v27, v27, v248
    v_mul_f32 v26, s60, v26
    v_mul_f32 v27, s60, v27
    v_exp_f32 v26, v26
    v_exp_f32 v27, v27
    s_nop 0
    v_add_f32 v253, v253, v26
    v_add_f32 v254, v254, v27
    v_cvt_pk_bf16_f32 v41, v26, v27
    v_sub_f32 v28, v28, v248
    v_sub_f32 v29, v29, v248
    v_mul_f32 v28, s60, v28
    v_mul_f32 v29, s60, v29
    v_exp_f32 v28, v28
    v_exp_f32 v29, v29
    s_nop 0
    v_add_f32 v253, v253, v28
    v_add_f32 v254, v254, v29
    v_cvt_pk_bf16_f32 v42, v28, v29
    v_sub_f32 v30, v30, v248
    v_sub_f32 v31, v31, v248
    v_mul_f32 v30, s60, v30
    v_mul_f32 v31, s60, v31
    v_exp_f32 v30, v30
    v_exp_f32 v31, v31
    s_nop 0
    v_add_f32 v253, v253, v30
    v_add_f32 v254, v254, v31
    v_cvt_pk_bf16_f32 v43, v30, v31
    v_add_f32 v253, v253, v254
    v_fma_f32 v249, v249, v252, v253
    v_mul_f32 v48, v48, v252
    v_mul_f32 v49, v49, v252
    v_mul_f32 v50, v50, v252
    v_mul_f32 v51, v51, v252
    v_mul_f32 v52, v52, v252
    v_mul_f32 v53, v53, v252
    v_mul_f32 v54, v54, v252
    v_mul_f32 v55, v55, v252
    v_mul_f32 v56, v56, v252
    v_mul_f32 v57, v57, v252
    v_mul_f32 v58, v58, v252
    v_mul_f32 v59, v59, v252
    v_mul_f32 v60, v60, v252
    v_mul_f32 v61, v61, v252
    v_mul_f32 v62, v62, v252
    v_mul_f32 v63, v63, v252
    v_mul_f32 v64, v64, v252
    v_mul_f32 v65, v65, v252
    v_mul_f32 v66, v66, v252
    v_mul_f32 v67, v67, v252
    v_mul_f32 v68, v68, v252
    v_mul_f32 v69, v69, v252
    v_mul_f32 v70, v70, v252
    v_mul_f32 v71, v71, v252
    v_mul_f32 v72, v72, v252
    v_mul_f32 v73, v73, v252
    v_mul_f32 v74, v74, v252
    v_mul_f32 v75, v75, v252
    v_mul_f32 v76, v76, v252
    v_mul_f32 v77, v77, v252
    v_mul_f32 v78, v78, v252
    v_mul_f32 v79, v79, v252
    s_waitcnt vmcnt(57)
    v_perm_b32 v24, v148, v144, s58
    v_perm_b32 v25, v156, v152, s58
    v_perm_b32 v26, v164, v160, s58
    v_perm_b32 v27, v172, v168, s58
    v_perm_b32 v28, v148, v144, s59
    v_perm_b32 v29, v156, v152, s59
    v_perm_b32 v30, v164, v160, s59
    v_perm_b32 v31, v172, v168, s59
    v_perm_b32 v32, v149, v145, s58
    v_perm_b32 v33, v157, v153, s58
    v_perm_b32 v34, v165, v161, s58
    v_perm_b32 v35, v173, v169, s58
    v_perm_b32 v36, v149, v145, s59
    v_perm_b32 v37, v157, v153, s59
    v_perm_b32 v38, v165, v161, s59
    v_perm_b32 v39, v173, v169, s59
    s_nop 1
    v_mfma_f32_16x16x32_bf16 v[48:51], v[24:27], v[40:43], v[48:51]
    v_mfma_f32_16x16x32_bf16 v[52:55], v[28:31], v[40:43], v[52:55]
    v_mfma_f32_16x16x32_bf16 v[56:59], v[32:35], v[40:43], v[56:59]
    v_mfma_f32_16x16x32_bf16 v[60:63], v[36:39], v[40:43], v[60:63]
    v_perm_b32 v24, v150, v146, s58
    v_perm_b32 v25, v158, v154, s58
    v_perm_b32 v26, v166, v162, s58
    v_perm_b32 v27, v174, v170, s58
    v_perm_b32 v28, v150, v146, s59
    v_perm_b32 v29, v158, v154, s59
    v_perm_b32 v30, v166, v162, s59
    v_perm_b32 v31, v174, v170, s59
    v_perm_b32 v32, v151, v147, s58
    v_perm_b32 v33, v159, v155, s58
    v_perm_b32 v34, v167, v163, s58
    v_perm_b32 v35, v175, v171, s58
    v_perm_b32 v36, v151, v147, s59
    v_perm_b32 v37, v159, v155, s59
    v_perm_b32 v38, v167, v163, s59
    v_perm_b32 v39, v175, v171, s59
    s_nop 1
    v_mfma_f32_16x16x32_bf16 v[64:67], v[24:27], v[40:43], v[64:67]
    v_mfma_f32_16x16x32_bf16 v[68:71], v[28:31], v[40:43], v[68:71]
    v_mfma_f32_16x16x32_bf16 v[72:75], v[32:35], v[40:43], v[72:75]
    v_mfma_f32_16x16x32_bf16 v[76:79], v[36:39], v[40:43], v[76:79]
    s_nop 7
    s_waitcnt vmcnt(12)
    s_add_u32 s46, s5, 0
    buffer_load_dwordx4 v[144:147], v2, s[32:35], s46 offen offset:0 nt
    buffer_load_dwordx4 v[148:151], v2, s[32:35], s46 offen offset:1024 nt
    buffer_load_dwordx4 v[152:155], v2, s[32:35], s46 offen offset:2048 nt
    buffer_load_dwordx4 v[156:159], v2, s[32:35], s46 offen offset:3072 nt
    s_waitcnt vmcnt(12)
    s_add_u32 s46, s5, 4096
    buffer_load_dwordx4 v[160:163], v2, s[32:35], s46 offen offset:0 nt
    buffer_load_dwordx4 v[164:167], v2, s[32:35], s46 offen offset:1024 nt
    buffer_load_dwordx4 v[168:171], v2, s[32:35], s46 offen offset:2048 nt
    buffer_load_dwordx4 v[172:175], v2, s[32:35], s46 offen offset:3072 nt
    s_waitcnt vmcnt(57)
    ds_read_b128 v[80:83], v244 offset:16384
    ds_read_b128 v[84:87], v245 offset:16384
    ds_read_b128 v[88:91], v246 offset:16384
    ds_read_b128 v[92:95], v247 offset:16384
    ds_read_b128 v[96:99], v244 offset:20480
    ds_read_b128 v[100:103], v245 offset:20480
    ds_read_b128 v[104:107], v246 offset:20480
    ds_read_b128 v[108:111], v247 offset:20480
    s_waitcnt lgkmcnt(4)
    v_mfma_f32_16x16x32_bf16 v[24:27], v[80:83], v[8:11], 0
    v_mfma_f32_16x16x32_bf16 v[24:27], v[84:87], v[12:15], v[24:27]
    v_mfma_f32_16x16x32_bf16 v[24:27], v[88:91], v[16:19], v[24:27]
    v_mfma_f32_16x16x32_bf16 v[24:27], v[92:95], v[20:23], v[24:27]
    s_waitcnt lgkmcnt(0)
    v_mfma_f32_16x16x32_bf16 v[28:31], v[96:99], v[8:11], 0
    v_mfma_f32_16x16x32_bf16 v[28:31], v[100:103], v[12:15], v[28:31]
    v_mfma_f32_16x16x32_bf16 v[28:31], v[104:107], v[16:19], v[28:31]
    v_mfma_f32_16x16x32_bf16 v[28:31], v[108:111], v[20:23], v[28:31]
    s_nop 7
    v_cvt_pk_bf16_f32 v250, v24, v25
    v_lshlrev_b32 v24, 16, v250
    v_and_b32 v25, 0xffff0000, v250
    v_mul_f32 v24, s61, v24
    v_mul_f32 v25, s61, v25
    v_cvt_pk_bf16_f32 v250, v24, v25
    v_lshlrev_b32 v24, 16, v250
    v_and_b32 v25, 0xffff0000, v250
    v_cvt_pk_bf16_f32 v250, v26, v27
    v_lshlrev_b32 v26, 16, v250
    v_and_b32 v27, 0xffff0000, v250
    v_mul_f32 v26, s61, v26
    v_mul_f32 v27, s61, v27
    v_cvt_pk_bf16_f32 v250, v26, v27
    v_lshlrev_b32 v26, 16, v250
    v_and_b32 v27, 0xffff0000, v250
    v_cvt_pk_bf16_f32 v250, v28, v29
    v_lshlrev_b32 v28, 16, v250
    v_and_b32 v29, 0xffff0000, v250
    v_mul_f32 v28, s61, v28
    v_mul_f32 v29, s61, v29
    v_cvt_pk_bf16_f32 v250, v28, v29
    v_lshlrev_b32 v28, 16, v250
    v_and_b32 v29, 0xffff0000, v250
    v_cvt_pk_bf16_f32 v250, v30, v31
    v_lshlrev_b32 v30, 16, v250
    v_and_b32 v31, 0xffff0000, v250
    v_mul_f32 v30, s61, v30
    v_mul_f32 v31, s61, v31
    v_cvt_pk_bf16_f32 v250, v30, v31
    v_lshlrev_b32 v30, 16, v250
    v_and_b32 v31, 0xffff0000, v250
    v_max3_f32 v250, v24, v25, v248
    v_max3_f32 v250, v250, v26, v27
    v_max3_f32 v250, v250, v28, v29
    v_max3_f32 v250, v250, v30, v31
    v_mov_b32 v251, v250
    s_nop 1
    v_permlane16_swap_b32 v250, v251
    s_nop 1
    v_max_f32 v250, v250, v251
    v_mov_b32 v251, v250
    s_nop 1
    v_permlane32_swap_b32 v250, v251
    s_nop 1
    v_max_f32 v250, v250, v251
    v_sub_f32 v252, v248, v250
    v_mul_f32 v252, s60, v252
    v_exp_f32 v252, v252
    v_mov_b32 v248, v250
    v_mov_b32 v253, 0
    v_mov_b32 v254, 0
    v_sub_f32 v24, v24, v248
    v_sub_f32 v25, v25, v248
    v_mul_f32 v24, s60, v24
    v_mul_f32 v25, s60, v25
    v_exp_f32 v24, v24
    v_exp_f32 v25, v25
    s_nop 0
    v_add_f32 v253, v253, v24
    v_add_f32 v254, v254, v25
    v_cvt_pk_bf16_f32 v40, v24, v25
    v_sub_f32 v26, v26, v248
    v_sub_f32 v27, v27, v248
    v_mul_f32 v26, s60, v26
    v_mul_f32 v27, s60, v27
    v_exp_f32 v26, v26
    v_exp_f32 v27, v27
    s_nop 0
    v_add_f32 v253, v253, v26
    v_add_f32 v254, v254, v27
    v_cvt_pk_bf16_f32 v41, v26, v27
    v_sub_f32 v28, v28, v248
    v_sub_f32 v29, v29, v248
    v_mul_f32 v28, s60, v28
    v_mul_f32 v29, s60, v29
    v_exp_f32 v28, v28
    v_exp_f32 v29, v29
    s_nop 0
    v_add_f32 v253, v253, v28
    v_add_f32 v254, v254, v29
    v_cvt_pk_bf16_f32 v42, v28, v29
    v_sub_f32 v30, v30, v248
    v_sub_f32 v31, v31, v248
    v_mul_f32 v30, s60, v30
    v_mul_f32 v31, s60, v31
    v_exp_f32 v30, v30
    v_exp_f32 v31, v31
    s_nop 0
    v_add_f32 v253, v253, v30
    v_add_f32 v254, v254, v31
    v_cvt_pk_bf16_f32 v43, v30, v31
    v_add_f32 v253, v253, v254
    v_fma_f32 v249, v249, v252, v253
    v_mul_f32 v48, v48, v252
    v_mul_f32 v49, v49, v252
    v_mul_f32 v50, v50, v252
    v_mul_f32 v51, v51, v252
    v_mul_f32 v52, v52, v252
    v_mul_f32 v53, v53, v252
    v_mul_f32 v54, v54, v252
    v_mul_f32 v55, v55, v252
    v_mul_f32 v56, v56, v252
    v_mul_f32 v57, v57, v252
    v_mul_f32 v58, v58, v252
    v_mul_f32 v59, v59, v252
    v_mul_f32 v60, v60, v252
    v_mul_f32 v61, v61, v252
    v_mul_f32 v62, v62, v252
    v_mul_f32 v63, v63, v252
    v_mul_f32 v64, v64, v252
    v_mul_f32 v65, v65, v252
    v_mul_f32 v66, v66, v252
    v_mul_f32 v67, v67, v252
    v_mul_f32 v68, v68, v252
    v_mul_f32 v69, v69, v252
    v_mul_f32 v70, v70, v252
    v_mul_f32 v71, v71, v252
    v_mul_f32 v72, v72, v252
    v_mul_f32 v73, v73, v252
    v_mul_f32 v74, v74, v252
    v_mul_f32 v75, v75, v252
    v_mul_f32 v76, v76, v252
    v_mul_f32 v77, v77, v252
    v_mul_f32 v78, v78, v252
    v_mul_f32 v79, v79, v252
    s_waitcnt vmcnt(49)
    v_perm_b32 v24, v180, v176, s58
    v_perm_b32 v25, v188, v184, s58
    v_perm_b32 v26, v196, v192, s58
    v_perm_b32 v27, v204, v200, s58
    v_perm_b32 v28, v180, v176, s59
    v_perm_b32 v29, v188, v184, s59
    v_perm_b32 v30, v196, v192, s59
    v_perm_b32 v31, v204, v200, s59
    v_perm_b32 v32, v181, v177, s58
    v_perm_b32 v33, v189, v185, s58
    v_perm_b32 v34, v197, v193, s58
    v_perm_b32 v35, v205, v201, s58
    v_perm_b32 v36, v181, v177, s59
    v_perm_b32 v37, v189, v185, s59
    v_perm_b32 v38, v197, v193, s59
    v_perm_b32 v39, v205, v201, s59
    s_nop 1
    v_mfma_f32_16x16x32_bf16 v[48:51], v[24:27], v[40:43], v[48:51]
    v_mfma_f32_16x16x32_bf16 v[52:55], v[28:31], v[40:43], v[52:55]
    v_mfma_f32_16x16x32_bf16 v[56:59], v[32:35], v[40:43], v[56:59]
    v_mfma_f32_16x16x32_bf16 v[60:63], v[36:39], v[40:43], v[60:63]
    v_perm_b32 v24, v182, v178, s58
    v_perm_b32 v25, v190, v186, s58
    v_perm_b32 v26, v198, v194, s58
    v_perm_b32 v27, v206, v202, s58
    v_perm_b32 v28, v182, v178, s59
    v_perm_b32 v29, v190, v186, s59
    v_perm_b32 v30, v198, v194, s59
    v_perm_b32 v31, v206, v202, s59
    v_perm_b32 v32, v183, v179, s58
    v_perm_b32 v33, v191, v187, s58
    v_perm_b32 v34, v199, v195, s58
    v_perm_b32 v35, v207, v203, s58
    v_perm_b32 v36, v183, v179, s59
    v_perm_b32 v37, v191, v187, s59
    v_perm_b32 v38, v199, v195, s59
    v_perm_b32 v39, v207, v203, s59
    s_nop 1
    v_mfma_f32_16x16x32_bf16 v[64:67], v[24:27], v[40:43], v[64:67]
    v_mfma_f32_16x16x32_bf16 v[68:71], v[28:31], v[40:43], v[68:71]
    v_mfma_f32_16x16x32_bf16 v[72:75], v[32:35], v[40:43], v[72:75]
    v_mfma_f32_16x16x32_bf16 v[76:79], v[36:39], v[40:43], v[76:79]
    s_nop 7
    s_waitcnt vmcnt(41)
    ds_read_b128 v[80:83], v244 offset:24576
    ds_read_b128 v[84:87], v245 offset:24576
    ds_read_b128 v[88:91], v246 offset:24576
    ds_read_b128 v[92:95], v247 offset:24576
    ds_read_b128 v[96:99], v244 offset:28672
    ds_read_b128 v[100:103], v245 offset:28672
    ds_read_b128 v[104:107], v246 offset:28672
    ds_read_b128 v[108:111], v247 offset:28672
    s_waitcnt lgkmcnt(4)
    v_mfma_f32_16x16x32_bf16 v[24:27], v[80:83], v[8:11], 0
    v_mfma_f32_16x16x32_bf16 v[24:27], v[84:87], v[12:15], v[24:27]
    v_mfma_f32_16x16x32_bf16 v[24:27], v[88:91], v[16:19], v[24:27]
    v_mfma_f32_16x16x32_bf16 v[24:27], v[92:95], v[20:23], v[24:27]
    s_waitcnt lgkmcnt(0)
    v_mfma_f32_16x16x32_bf16 v[28:31], v[96:99], v[8:11], 0
    v_mfma_f32_16x16x32_bf16 v[28:31], v[100:103], v[12:15], v[28:31]
    v_mfma_f32_16x16x32_bf16 v[28:31], v[104:107], v[16:19], v[28:31]
    v_mfma_f32_16x16x32_bf16 v[28:31], v[108:111], v[20:23], v[28:31]
    s_nop 7
    v_cvt_pk_bf16_f32 v250, v24, v25
    v_lshlrev_b32 v24, 16, v250
    v_and_b32 v25, 0xffff0000, v250
    v_mul_f32 v24, s61, v24
    v_mul_f32 v25, s61, v25
    v_cvt_pk_bf16_f32 v250, v24, v25
    v_lshlrev_b32 v24, 16, v250
    v_and_b32 v25, 0xffff0000, v250
    v_cvt_pk_bf16_f32 v250, v26, v27
    v_lshlrev_b32 v26, 16, v250
    v_and_b32 v27, 0xffff0000, v250
    v_mul_f32 v26, s61, v26
    v_mul_f32 v27, s61, v27
    v_cvt_pk_bf16_f32 v250, v26, v27
    v_lshlrev_b32 v26, 16, v250
    v_and_b32 v27, 0xffff0000, v250
    v_cvt_pk_bf16_f32 v250, v28, v29
    v_lshlrev_b32 v28, 16, v250
    v_and_b32 v29, 0xffff0000, v250
    v_mul_f32 v28, s61, v28
    v_mul_f32 v29, s61, v29
    v_cvt_pk_bf16_f32 v250, v28, v29
    v_lshlrev_b32 v28, 16, v250
    v_and_b32 v29, 0xffff0000, v250
    v_cvt_pk_bf16_f32 v250, v30, v31
    v_lshlrev_b32 v30, 16, v250
    v_and_b32 v31, 0xffff0000, v250
    v_mul_f32 v30, s61, v30
    v_mul_f32 v31, s61, v31
    v_cvt_pk_bf16_f32 v250, v30, v31
    v_lshlrev_b32 v30, 16, v250
    v_and_b32 v31, 0xffff0000, v250
    v_max3_f32 v250, v24, v25, v248
    v_max3_f32 v250, v250, v26, v27
    v_max3_f32 v250, v250, v28, v29
    v_max3_f32 v250, v250, v30, v31
    v_mov_b32 v251, v250
    s_nop 1
    v_permlane16_swap_b32 v250, v251
    s_nop 1
    v_max_f32 v250, v250, v251
    v_mov_b32 v251, v250
    s_nop 1
    v_permlane32_swap_b32 v250, v251
    s_nop 1
    v_max_f32 v250, v250, v251
    v_sub_f32 v252, v248, v250
    v_mul_f32 v252, s60, v252
    v_exp_f32 v252, v252
    v_mov_b32 v248, v250
    v_mov_b32 v253, 0
    v_mov_b32 v254, 0
    v_sub_f32 v24, v24, v248
    v_sub_f32 v25, v25, v248
    v_mul_f32 v24, s60, v24
    v_mul_f32 v25, s60, v25
    v_exp_f32 v24, v24
    v_exp_f32 v25, v25
    s_nop 0
    v_add_f32 v253, v253, v24
    v_add_f32 v254, v254, v25
    v_cvt_pk_bf16_f32 v40, v24, v25
    v_sub_f32 v26, v26, v248
    v_sub_f32 v27, v27, v248
    v_mul_f32 v26, s60, v26
    v_mul_f32 v27, s60, v27
    v_exp_f32 v26, v26
    v_exp_f32 v27, v27
    s_nop 0
    v_add_f32 v253, v253, v26
    v_add_f32 v254, v254, v27
    v_cvt_pk_bf16_f32 v41, v26, v27
    v_sub_f32 v28, v28, v248
    v_sub_f32 v29, v29, v248
    v_mul_f32 v28, s60, v28
    v_mul_f32 v29, s60, v29
    v_exp_f32 v28, v28
    v_exp_f32 v29, v29
    s_nop 0
    v_add_f32 v253, v253, v28
    v_add_f32 v254, v254, v29
    v_cvt_pk_bf16_f32 v42, v28, v29
    v_sub_f32 v30, v30, v248
    v_sub_f32 v31, v31, v248
    v_mul_f32 v30, s60, v30
    v_mul_f32 v31, s60, v31
    v_exp_f32 v30, v30
    v_exp_f32 v31, v31
    s_nop 0
    v_add_f32 v253, v253, v30
    v_add_f32 v254, v254, v31
    v_cvt_pk_bf16_f32 v43, v30, v31
    v_add_f32 v253, v253, v254
    v_fma_f32 v249, v249, v252, v253
    v_mul_f32 v48, v48, v252
    v_mul_f32 v49, v49, v252
    v_mul_f32 v50, v50, v252
    v_mul_f32 v51, v51, v252
    v_mul_f32 v52, v52, v252
    v_mul_f32 v53, v53, v252
    v_mul_f32 v54, v54, v252
    v_mul_f32 v55, v55, v252
    v_mul_f32 v56, v56, v252
    v_mul_f32 v57, v57, v252
    v_mul_f32 v58, v58, v252
    v_mul_f32 v59, v59, v252
    v_mul_f32 v60, v60, v252
    v_mul_f32 v61, v61, v252
    v_mul_f32 v62, v62, v252
    v_mul_f32 v63, v63, v252
    v_mul_f32 v64, v64, v252
    v_mul_f32 v65, v65, v252
    v_mul_f32 v66, v66, v252
    v_mul_f32 v67, v67, v252
    v_mul_f32 v68, v68, v252
    v_mul_f32 v69, v69, v252
    v_mul_f32 v70, v70, v252
    v_mul_f32 v71, v71, v252
    v_mul_f32 v72, v72, v252
    v_mul_f32 v73, v73, v252
    v_mul_f32 v74, v74, v252
    v_mul_f32 v75, v75, v252
    v_mul_f32 v76, v76, v252
    v_mul_f32 v77, v77, v252
    v_mul_f32 v78, v78, v252
    v_mul_f32 v79, v79, v252
    s_waitcnt vmcnt(33)
    v_perm_b32 v24, v212, v208, s58
    v_perm_b32 v25, v220, v216, s58
    v_perm_b32 v26, v228, v224, s58
    v_perm_b32 v27, v236, v232, s58
    v_perm_b32 v28, v212, v208, s59
    v_perm_b32 v29, v220, v216, s59
    v_perm_b32 v30, v228, v224, s59
    v_perm_b32 v31, v236, v232, s59
    v_perm_b32 v32, v213, v209, s58
    v_perm_b32 v33, v221, v217, s58
    v_perm_b32 v34, v229, v225, s58
    v_perm_b32 v35, v237, v233, s58
    v_perm_b32 v36, v213, v209, s59
    v_perm_b32 v37, v221, v217, s59
    v_perm_b32 v38, v229, v225, s59
    v_perm_b32 v39, v237, v233, s59
    s_nop 1
    v_mfma_f32_16x16x32_bf16 v[48:51], v[24:27], v[40:43], v[48:51]
    v_mfma_f32_16x16x32_bf16 v[52:55], v[28:31], v[40:43], v[52:55]
    v_mfma_f32_16x16x32_bf16 v[56:59], v[32:35], v[40:43], v[56:59]
    v_mfma_f32_16x16x32_bf16 v[60:63], v[36:39], v[40:43], v[60:63]
    v_perm_b32 v24, v214, v210, s58
    v_perm_b32 v25, v222, v218, s58
    v_perm_b32 v26, v230, v226, s58
    v_perm_b32 v27, v238, v234, s58
    v_perm_b32 v28, v214, v210, s59
    v_perm_b32 v29, v222, v218, s59
    v_perm_b32 v30, v230, v226, s59
    v_perm_b32 v31, v238, v234, s59
    v_perm_b32 v32, v215, v211, s58
    v_perm_b32 v33, v223, v219, s58
    v_perm_b32 v34, v231, v227, s58
    v_perm_b32 v35, v239, v235, s58
    v_perm_b32 v36, v215, v211, s59
    v_perm_b32 v37, v223, v219, s59
    v_perm_b32 v38, v231, v227, s59
    v_perm_b32 v39, v239, v235, s59
    s_nop 1
    v_mfma_f32_16x16x32_bf16 v[64:67], v[24:27], v[40:43], v[64:67]
    v_mfma_f32_16x16x32_bf16 v[68:71], v[28:31], v[40:43], v[68:71]
    v_mfma_f32_16x16x32_bf16 v[72:75], v[32:35], v[40:43], v[72:75]
    v_mfma_f32_16x16x32_bf16 v[76:79], v[36:39], v[40:43], v[76:79]
    s_nop 7
    s_mov_b32 s7, 1
    s_mov_b32 s8, 1
L_SLOOP:
    s_cmp_eq_u32 s7, 0
    s_cbranch_scc1 H_61_w0
    s_waitcnt vmcnt(24)
    s_branch H_61_w1
H_61_w0:
    s_waitcnt vmcnt(8)
H_61_w1:
    ds_read_b128 v[80:83], v244 offset:0
    ds_read_b128 v[84:87], v245 offset:0
    ds_read_b128 v[88:91], v246 offset:0
    ds_read_b128 v[92:95], v247 offset:0
    ds_read_b128 v[96:99], v244 offset:4096
    ds_read_b128 v[100:103], v245 offset:4096
    ds_read_b128 v[104:107], v246 offset:4096
    ds_read_b128 v[108:111], v247 offset:4096
    s_waitcnt lgkmcnt(4)
    v_mfma_f32_16x16x32_bf16 v[24:27], v[80:83], v[8:11], 0
    v_mfma_f32_16x16x32_bf16 v[24:27], v[84:87], v[12:15], v[24:27]
    v_mfma_f32_16x16x32_bf16 v[24:27], v[88:91], v[16:19], v[24:27]
    v_mfma_f32_16x16x32_bf16 v[24:27], v[92:95], v[20:23], v[24:27]
    s_waitcnt lgkmcnt(0)
    v_mfma_f32_16x16x32_bf16 v[28:31], v[96:99], v[8:11], 0
    v_mfma_f32_16x16x32_bf16 v[28:31], v[100:103], v[12:15], v[28:31]
    v_mfma_f32_16x16x32_bf16 v[28:31], v[104:107], v[16:19], v[28:31]
    v_mfma_f32_16x16x32_bf16 v[28:31], v[108:111], v[20:23], v[28:31]
    s_mov_b32 s9, 0
    s_cmp_eq_u32 s8, 0
    s_cbranch_scc1 H_61_nok
    s_waitcnt vmcnt(16)
    v_readfirstlane_b32 s11, v255
    s_mov_b32 s8, 0
    s_cmp_ge_u32 s11, 256
    s_cbranch_scc1 H_61_nok
    s_mov_b32 s9, 1
    s_and_b32 s10, s11, 127
    s_lshr_b32 s10, s10, 2
    s_lshl_b32 s10, s10, 18
    s_and_b32 s12, s11, 3
    s_lshl_b32 s12, s12, 13
    s_add_u32 s10, s10, s12
    s_lshr_b32 s12, s11, 7
    s_add_u32 s12, s12, 6
    s_lshl_b32 s12, s12, 15
    s_add_u32 s10, s10, s12
    s_add_u32 s10, s10, s4
    v_mov_b32 v255, 1
    s_mov_b64 exec, 1
    buffer_atomic_add v255, v1, s[36:39], 0 offen sc0
    s_mov_b64 exec, -1
    s_mov_b32 s8, 1
    s_waitcnt vmcnt(12)
    s_add_u32 s46, s10, 0
    s_add_u32 s49, s48, 0
    s_mov_b32 m0, s49
    s_nop 0
    buffer_load_dwordx4 v240, s[28:31], s46 offen nt lds
    s_add_u32 s49, s48, 1024
    s_mov_b32 m0, s49
    s_nop 0
    buffer_load_dwordx4 v241, s[28:31], s46 offen nt lds
    s_add_u32 s49, s48, 2048
    s_mov_b32 m0, s49
    s_nop 0
    buffer_load_dwordx4 v242, s[28:31], s46 offen nt lds
    s_add_u32 s49, s48, 3072
    s_mov_b32 m0, s49
    s_nop 0
    buffer_load_dwordx4 v243, s[28:31], s46 offen nt lds
    s_waitcnt vmcnt(12)
    s_add_u32 s46, s10, 4096
    s_add_u32 s49, s48, 4096
    s_mov_b32 m0, s49
    s_nop 0
    buffer_load_dwordx4 v240, s[28:31], s46 offen nt lds
    s_add_u32 s49, s48, 5120
    s_mov_b32 m0, s49
    s_nop 0
    buffer_load_dwordx4 v241, s[28:31], s46 offen nt lds
    s_add_u32 s49, s48, 6144
    s_mov_b32 m0, s49
    s_nop 0
    buffer_load_dwordx4 v242, s[28:31], s46 offen nt lds
    s_add_u32 s49, s48, 7168
    s_mov_b32 m0, s49
    s_nop 0
    buffer_load_dwordx4 v243, s[28:31], s46 offen nt lds
H_61_nok:
    s_nop 7
    v_cvt_pk_bf16_f32 v250, v24, v25
    v_lshlrev_b32 v24, 16, v250
    v_and_b32 v25, 0xffff0000, v250
    v_mul_f32 v24, s61, v24
    v_mul_f32 v25, s61, v25
    v_cvt_pk_bf16_f32 v250, v24, v25
    v_lshlrev_b32 v24, 16, v250
    v_and_b32 v25, 0xffff0000, v250
    v_cvt_pk_bf16_f32 v250, v26, v27
    v_lshlrev_b32 v26, 16, v250
    v_and_b32 v27, 0xffff0000, v250
    v_mul_f32 v26, s61, v26
    v_mul_f32 v27, s61, v27
    v_cvt_pk_bf16_f32 v250, v26, v27
    v_lshlrev_b32 v26, 16, v250
    v_and_b32 v27, 0xffff0000, v250
    v_cvt_pk_bf16_f32 v250, v28, v29
    v_lshlrev_b32 v28, 16, v250
    v_and_b32 v29, 0xffff0000, v250
    v_mul_f32 v28, s61, v28
    v_mul_f32 v29, s61, v29
    v_cvt_pk_bf16_f32 v250, v28, v29
    v_lshlrev_b32 v28, 16, v250
    v_and_b32 v29, 0xffff0000, v250
    v_cvt_pk_bf16_f32 v250, v30, v31
    v_lshlrev_b32 v30, 16, v250
    v_and_b32 v31, 0xffff0000, v250
    v_mul_f32 v30, s61, v30
    v_mul_f32 v31, s61, v31
    v_cvt_pk_bf16_f32 v250, v30, v31
    v_lshlrev_b32 v30, 16, v250
    v_and_b32 v31, 0xffff0000, v250
    v_max3_f32 v250, v24, v25, v248
    v_max3_f32 v250, v250, v26, v27
    v_max3_f32 v250, v250, v28, v29
    v_max3_f32 v250, v250, v30, v31
    v_mov_b32 v251, v250
    s_nop 1
    v_permlane16_swap_b32 v250, v251
    s_nop 1
    v_max_f32 v250, v250, v251
    v_mov_b32 v251, v250
    s_nop 1
    v_permlane32_swap_b32 v250, v251
    s_nop 1
    v_max_f32 v250, v250, v251
    v_sub_f32 v252, v248, v250
    v_mul_f32 v252, s60, v252
    v_exp_f32 v252, v252
    v_mov_b32 v248, v250
    v_mov_b32 v253, 0
    v_mov_b32 v254, 0
    v_sub_f32 v24, v24, v248
    v_sub_f32 v25, v25, v248
    v_mul_f32 v24, s60, v24
    v_mul_f32 v25, s60, v25
    v_exp_f32 v24, v24
    v_exp_f32 v25, v25
    s_nop 0
    v_add_f32 v253, v253, v24
    v_add_f32 v254, v254, v25
    v_cvt_pk_bf16_f32 v40, v24, v25
    v_sub_f32 v26, v26, v248
    v_sub_f32 v27, v27, v248
    v_mul_f32 v26, s60, v26
    v_mul_f32 v27, s60, v27
    v_exp_f32 v26, v26
    v_exp_f32 v27, v27
    s_nop 0
    v_add_f32 v253, v253, v26
    v_add_f32 v254, v254, v27
    v_cvt_pk_bf16_f32 v41, v26, v27
    v_sub_f32 v28, v28, v248
    v_sub_f32 v29, v29, v248
    v_mul_f32 v28, s60, v28
    v_mul_f32 v29, s60, v29
    v_exp_f32 v28, v28
    v_exp_f32 v29, v29
    s_nop 0
    v_add_f32 v253, v253, v28
    v_add_f32 v254, v254, v29
    v_cvt_pk_bf16_f32 v42, v28, v29
    v_sub_f32 v30, v30, v248
    v_sub_f32 v31, v31, v248
    v_mul_f32 v30, s60, v30
    v_mul_f32 v31, s60, v31
    v_exp_f32 v30, v30
    v_exp_f32 v31, v31
    s_nop 0
    v_add_f32 v253, v253, v30
    v_add_f32 v254, v254, v31
    v_cvt_pk_bf16_f32 v43, v30, v31
    v_add_f32 v253, v253, v254
    v_fma_f32 v249, v249, v252, v253
    v_mul_f32 v48, v48, v252
    v_mul_f32 v49, v49, v252
    v_mul_f32 v50, v50, v252
    v_mul_f32 v51, v51, v252
    v_mul_f32 v52, v52, v252
    v_mul_f32 v53, v53, v252
    v_mul_f32 v54, v54, v252
    v_mul_f32 v55, v55, v252
    v_mul_f32 v56, v56, v252
    v_mul_f32 v57, v57, v252
    v_mul_f32 v58, v58, v252
    v_mul_f32 v59, v59, v252
    v_mul_f32 v60, v60, v252
    v_mul_f32 v61, v61, v252
    v_mul_f32 v62, v62, v252
    v_mul_f32 v63, v63, v252
    v_mul_f32 v64, v64, v252
    v_mul_f32 v65, v65, v252
    v_mul_f32 v66, v66, v252
    v_mul_f32 v67, v67, v252
    v_mul_f32 v68, v68, v252
    v_mul_f32 v69, v69, v252
    v_mul_f32 v70, v70, v252
    v_mul_f32 v71, v71, v252
    v_mul_f32 v72, v72, v252
    v_mul_f32 v73, v73, v252
    v_mul_f32 v74, v74, v252
    v_mul_f32 v75, v75, v252
    v_mul_f32 v76, v76, v252
    v_mul_f32 v77, v77, v252
    v_mul_f32 v78, v78, v252
    v_mul_f32 v79, v79, v252
    s_lshl_b32 s12, s7, 1
    s_add_u32 s12, s12, s9
    s_cmp_eq_u32 s12, 3
    s_cbranch_scc1 H_61_v3
    s_cmp_eq_u32 s12, 2
    s_cbranch_scc1 H_61_v2
    s_cmp_eq_u32 s12, 1
    s_cbranch_scc1 H_61_v1
    s_waitcnt vmcnt(0)
    s_branch H_61_vd
H_61_v3:
    s_waitcnt vmcnt(24)
    s_branch H_61_vd
H_61_v2:
    s_waitcnt vmcnt(16)
    s_branch H_61_vd
H_61_v1:
    s_waitcnt vmcnt(8)
H_61_vd:
    v_perm_b32 v24, v116, v112, s58
    v_perm_b32 v25, v124, v120, s58
    v_perm_b32 v26, v132, v128, s58
    v_perm_b32 v27, v140, v136, s58
    v_perm_b32 v28, v116, v112, s59
    v_perm_b32 v29, v124, v120, s59
    v_perm_b32 v30, v132, v128, s59
    v_perm_b32 v31, v140, v136, s59
    v_perm_b32 v32, v117, v113, s58
    v_perm_b32 v33, v125, v121, s58
    v_perm_b32 v34, v133, v129, s58
    v_perm_b32 v35, v141, v137, s58
    v_perm_b32 v36, v117, v113, s59
    v_perm_b32 v37, v125, v121, s59
    v_perm_b32 v38, v133, v129, s59
    v_perm_b32 v39, v141, v137, s59
    s_nop 1
    v_mfma_f32_16x16x32_bf16 v[48:51], v[24:27], v[40:43], v[48:51]
    v_mfma_f32_16x16x32_bf16 v[52:55], v[28:31], v[40:43], v[52:55]
    v_mfma_f32_16x16x32_bf16 v[56:59], v[32:35], v[40:43], v[56:59]
    v_mfma_f32_16x16x32_bf16 v[60:63], v[36:39], v[40:43], v[60:63]
    v_perm_b32 v24, v118, v114, s58
    v_perm_b32 v25, v126, v122, s58
    v_perm_b32 v26, v134, v130, s58
    v_perm_b32 v27, v142, v138, s58
    v_perm_b32 v28, v118, v114, s59
    v_perm_b32 v29, v126, v122, s59
    v_perm_b32 v30, v134, v130, s59
    v_perm_b32 v31, v142, v138, s59
    v_perm_b32 v32, v119, v115, s58
    v_perm_b32 v33, v127, v123, s58
    v_perm_b32 v34, v135, v131, s58
    v_perm_b32 v35, v143, v139, s58
    v_perm_b32 v36, v119, v115, s59
    v_perm_b32 v37, v127, v123, s59
    v_perm_b32 v38, v135, v131, s59
    v_perm_b32 v39, v143, v139, s59
    s_nop 1
    v_mfma_f32_16x16x32_bf16 v[64:67], v[24:27], v[40:43], v[64:67]
    v_mfma_f32_16x16x32_bf16 v[68:71], v[28:31], v[40:43], v[68:71]
    v_mfma_f32_16x16x32_bf16 v[72:75], v[32:35], v[40:43], v[72:75]
    v_mfma_f32_16x16x32_bf16 v[76:79], v[36:39], v[40:43], v[76:79]
    s_nop 7
    s_cmp_eq_u32 s9, 0
    s_cbranch_scc1 H_61_nov
    s_waitcnt vmcnt(12)
    s_add_u32 s46, s10, 0
    buffer_load_dwordx4 v[112:115], v2, s[32:35], s46 offen offset:0 nt
    buffer_load_dwordx4 v[116:119], v2, s[32:35], s46 offen offset:1024 nt
    buffer_load_dwordx4 v[120:123], v2, s[32:35], s46 offen offset:2048 nt
    buffer_load_dwordx4 v[124:127], v2, s[32:35], s46 offen offset:3072 nt
    s_waitcnt vmcnt(12)
    s_add_u32 s46, s10, 4096
    buffer_load_dwordx4 v[128:131], v2, s[32:35], s46 offen offset:0 nt
    buffer_load_dwordx4 v[132:135], v2, s[32:35], s46 offen offset:1024 nt
    buffer_load_dwordx4 v[136:139], v2, s[32:35], s46 offen offset:2048 nt
    buffer_load_dwordx4 v[140:143], v2, s[32:35], s46 offen offset:3072 nt
    s_branch H_61_cont
H_61_nov:
    s_cmp_eq_u32 s7, 0
    s_cbranch_scc1 H_61_cont
    s_waitcnt lgkmcnt(0)
    v_mov_b32 v6, 6756
    v_mov_b32 v7, 1
    s_mov_b64 exec, 1
    ds_add_u32 v6, v7
    s_mov_b64 exec, -1
H_61_cont:
    s_mov_b32 s12, s7
    s_mov_b32 s7, s9
    s_cmp_eq_u32 s12, 0
    s_cbranch_scc1 L_SEXIT
    s_cmp_eq_u32 s7, 0
    s_cbranch_scc1 H_62_w0
    s_waitcnt vmcnt(24)
    s_branch H_62_w1
H_62_w0:
    s_waitcnt vmcnt(8)
H_62_w1:
    ds_read_b128 v[80:83], v244 offset:8192
    ds_read_b128 v[84:87], v245 offset:8192
    ds_read_b128 v[88:91], v246 offset:8192
    ds_read_b128 v[92:95], v247 offset:8192
    ds_read_b128 v[96:99], v244 offset:12288
    ds_read_b128 v[100:103], v245 offset:12288
    ds_read_b128 v[104:107], v246 offset:12288
    ds_read_b128 v[108:111], v247 offset:12288
    s_waitcnt lgkmcnt(4)
    v_mfma_f32_16x16x32_bf16 v[24:27], v[80:83], v[8:11], 0
    v_mfma_f32_16x16x32_bf16 v[24:27], v[84:87], v[12:15], v[24:27]
    v_mfma_f32_16x16x32_bf16 v[24:27], v[88:91], v[16:19], v[24:27]
    v_mfma_f32_16x16x32_bf16 v[24:27], v[92:95], v[20:23], v[24:27]
    s_waitcnt lgkmcnt(0)
    v_mfma_f32_16x16x32_bf16 v[28:31], v[96:99], v[8:11], 0
    v_mfma_f32_16x16x32_bf16 v[28:31], v[100:103], v[12:15], v[28:31]
    v_mfma_f32_16x16x32_bf16 v[28:31], v[104:107], v[16:19], v[28:31]
    v_mfma_f32_16x16x32_bf16 v[28:31], v[108:111], v[20:23], v[28:31]
    s_mov_b32 s9, 0
    s_cmp_eq_u32 s8, 0
    s_cbranch_scc1 H_62_nok
    s_waitcnt vmcnt(16)
    v_readfirstlane_b32 s11, v255
    s_mov_b32 s8, 0
    s_cmp_ge_u32 s11, 256
    s_cbranch_scc1 H_62_nok
    s_mov_b32 s9, 1
    s_and_b32 s10, s11, 127
    s_lshr_b32 s10, s10, 2
    s_lshl_b32 s10, s10, 18
    s_and_b32 s12, s11, 3
    s_lshl_b32 s12, s12, 13
    s_add_u32 s10, s10, s12
    s_lshr_b32 s12, s11, 7
    s_add_u32 s12, s12, 6
    s_lshl_b32 s12, s12, 15
    s_add_u32 s10, s10, s12
    s_add_u32 s10, s10, s4
    v_mov_b32 v255, 1
    s_mov_b64 exec, 1
    buffer_atomic_add v255, v1, s[36:39], 0 offen sc0
    s_mov_b64 exec, -1
    s_mov_b32 s8, 1
    s_waitcnt vmcnt(12)
    s_add_u32 s46, s10, 0
    s_add_u32 s49, s48, 8192
    s_mov_b32 m0, s49
    s_nop 0
    buffer_load_dwordx4 v240, s[28:31], s46 offen nt lds
    s_add_u32 s49, s48, 9216
    s_mov_b32 m0, s49
    s_nop 0
    buffer_load_dwordx4 v241, s[28:31], s46 offen nt lds
    s_add_u32 s49, s48, 10240
    s_mov_b32 m0, s49
    s_nop 0
    buffer_load_dwordx4 v242, s[28:31], s46 offen nt lds
    s_add_u32 s49, s48, 11264
    s_mov_b32 m0, s49
    s_nop 0
    buffer_load_dwordx4 v243, s[28:31], s46 offen nt lds
    s_waitcnt vmcnt(12)
    s_add_u32 s46, s10, 4096
    s_add_u32 s49, s48, 12288
    s_mov_b32 m0, s49
    s_nop 0
    buffer_load_dwordx4 v240, s[28:31], s46 offen nt lds
    s_add_u32 s49, s48, 13312
    s_mov_b32 m0, s49
    s_nop 0
    buffer_load_dwordx4 v241, s[28:31], s46 offen nt lds
    s_add_u32 s49, s48, 14336
    s_mov_b32 m0, s49
    s_nop 0
    buffer_load_dwordx4 v242, s[28:31], s46 offen nt lds
    s_add_u32 s49, s48, 15360
    s_mov_b32 m0, s49
    s_nop 0
    buffer_load_dwordx4 v243, s[28:31], s46 offen nt lds
H_62_nok:
    s_nop 7
    v_cvt_pk_bf16_f32 v250, v24, v25
    v_lshlrev_b32 v24, 16, v250
    v_and_b32 v25, 0xffff0000, v250
    v_mul_f32 v24, s61, v24
    v_mul_f32 v25, s61, v25
    v_cvt_pk_bf16_f32 v250, v24, v25
    v_lshlrev_b32 v24, 16, v250
    v_and_b32 v25, 0xffff0000, v250
    v_cvt_pk_bf16_f32 v250, v26, v27
    v_lshlrev_b32 v26, 16, v250
    v_and_b32 v27, 0xffff0000, v250
    v_mul_f32 v26, s61, v26
    v_mul_f32 v27, s61, v27
    v_cvt_pk_bf16_f32 v250, v26, v27
    v_lshlrev_b32 v26, 16, v250
    v_and_b32 v27, 0xffff0000, v250
    v_cvt_pk_bf16_f32 v250, v28, v29
    v_lshlrev_b32 v28, 16, v250
    v_and_b32 v29, 0xffff0000, v250
    v_mul_f32 v28, s61, v28
    v_mul_f32 v29, s61, v29
    v_cvt_pk_bf16_f32 v250, v28, v29
    v_lshlrev_b32 v28, 16, v250
    v_and_b32 v29, 0xffff0000, v250
    v_cvt_pk_bf16_f32 v250, v30, v31
    v_lshlrev_b32 v30, 16, v250
    v_and_b32 v31, 0xffff0000, v250
    v_mul_f32 v30, s61, v30
    v_mul_f32 v31, s61, v31
    v_cvt_pk_bf16_f32 v250, v30, v31
    v_lshlrev_b32 v30, 16, v250
    v_and_b32 v31, 0xffff0000, v250
    v_max3_f32 v250, v24, v25, v248
    v_max3_f32 v250, v250, v26, v27
    v_max3_f32 v250, v250, v28, v29
    v_max3_f32 v250, v250, v30, v31
    v_mov_b32 v251, v250
    s_nop 1
    v_permlane16_swap_b32 v250, v251
    s_nop 1
    v_max_f32 v250, v250, v251
    v_mov_b32 v251, v250
    s_nop 1
    v_permlane32_swap_b32 v250, v251
    s_nop 1
    v_max_f32 v250, v250, v251
    v_sub_f32 v252, v248, v250
    v_mul_f32 v252, s60, v252
    v_exp_f32 v252, v252
    v_mov_b32 v248, v250
    v_mov_b32 v253, 0
    v_mov_b32 v254, 0
    v_sub_f32 v24, v24, v248
    v_sub_f32 v25, v25, v248
    v_mul_f32 v24, s60, v24
    v_mul_f32 v25, s60, v25
    v_exp_f32 v24, v24
    v_exp_f32 v25, v25
    s_nop 0
    v_add_f32 v253, v253, v24
    v_add_f32 v254, v254, v25
    v_cvt_pk_bf16_f32 v40, v24, v25
    v_sub_f32 v26, v26, v248
    v_sub_f32 v27, v27, v248
    v_mul_f32 v26, s60, v26
    v_mul_f32 v27, s60, v27
    v_exp_f32 v26, v26
    v_exp_f32 v27, v27
    s_nop 0
    v_add_f32 v253, v253, v26
    v_add_f32 v254, v254, v27
    v_cvt_pk_bf16_f32 v41, v26, v27
    v_sub_f32 v28, v28, v248
    v_sub_f32 v29, v29, v248
    v_mul_f32 v28, s60, v28
    v_mul_f32 v29, s60, v29
    v_exp_f32 v28, v28
    v_exp_f32 v29, v29
    s_nop 0
    v_add_f32 v253, v253, v28
    v_add_f32 v254, v254, v29
    v_cvt_pk_bf16_f32 v42, v28, v29
    v_sub_f32 v30, v30, v248
    v_sub_f32 v31, v31, v248
    v_mul_f32 v30, s60, v30
    v_mul_f32 v31, s60, v31
    v_exp_f32 v30, v30
    v_exp_f32 v31, v31
    s_nop 0
    v_add_f32 v253, v253, v30
    v_add_f32 v254, v254, v31
    v_cvt_pk_bf16_f32 v43, v30, v31
    v_add_f32 v253, v253, v254
    v_fma_f32 v249, v249, v252, v253
    v_mul_f32 v48, v48, v252
    v_mul_f32 v49, v49, v252
    v_mul_f32 v50, v50, v252
    v_mul_f32 v51, v51, v252
    v_mul_f32 v52, v52, v252
    v_mul_f32 v53, v53, v252
    v_mul_f32 v54, v54, v252
    v_mul_f32 v55, v55, v252
    v_mul_f32 v56, v56, v252
    v_mul_f32 v57, v57, v252
    v_mul_f32 v58, v58, v252
    v_mul_f32 v59, v59, v252
    v_mul_f32 v60, v60, v252
    v_mul_f32 v61, v61, v252
    v_mul_f32 v62, v62, v252
    v_mul_f32 v63, v63, v252
    v_mul_f32 v64, v64, v252
    v_mul_f32 v65, v65, v252
    v_mul_f32 v66, v66, v252
    v_mul_f32 v67, v67, v252
    v_mul_f32 v68, v68, v252
    v_mul_f32 v69, v69, v252
    v_mul_f32 v70, v70, v252
    v_mul_f32 v71, v71, v252
    v_mul_f32 v72, v72, v252
    v_mul_f32 v73, v73, v252
    v_mul_f32 v74, v74, v252
    v_mul_f32 v75, v75, v252
    v_mul_f32 v76, v76, v252
    v_mul_f32 v77, v77, v252
    v_mul_f32 v78, v78, v252
    v_mul_f32 v79, v79, v252
    s_lshl_b32 s12, s7, 1
    s_add_u32 s12, s12, s9
    s_cmp_eq_u32 s12, 3
    s_cbranch_scc1 H_62_v3
    s_cmp_eq_u32 s12, 2
    s_cbranch_scc1 H_62_v2
    s_cmp_eq_u32 s12, 1
    s_cbranch_scc1 H_62_v1
    s_waitcnt vmcnt(0)
    s_branch H_62_vd
H_62_v3:
    s_waitcnt vmcnt(24)
    s_branch H_62_vd
H_62_v2:
    s_waitcnt vmcnt(16)
    s_branch H_62_vd
H_62_v1:
    s_waitcnt vmcnt(8)
H_62_vd:
    v_perm_b32 v24, v148, v144, s58
    v_perm_b32 v25, v156, v152, s58
    v_perm_b32 v26, v164, v160, s58
    v_perm_b32 v27, v172, v168, s58
    v_perm_b32 v28, v148, v144, s59
    v_perm_b32 v29, v156, v152, s59
    v_perm_b32 v30, v164, v160, s59
    v_perm_b32 v31, v172, v168, s59
    v_perm_b32 v32, v149, v145, s58
    v_perm_b32 v33, v157, v153, s58
    v_perm_b32 v34, v165, v161, s58
    v_perm_b32 v35, v173, v169, s58
    v_perm_b32 v36, v149, v145, s59
    v_perm_b32 v37, v157, v153, s59
    v_perm_b32 v38, v165, v161, s59
    v_perm_b32 v39, v173, v169, s59
    s_nop 1
    v_mfma_f32_16x16x32_bf16 v[48:51], v[24:27], v[40:43], v[48:51]
    v_mfma_f32_16x16x32_bf16 v[52:55], v[28:31], v[40:43], v[52:55]
    v_mfma_f32_16x16x32_bf16 v[56:59], v[32:35], v[40:43], v[56:59]
    v_mfma_f32_16x16x32_bf16 v[60:63], v[36:39], v[40:43], v[60:63]
    v_perm_b32 v24, v150, v146, s58
    v_perm_b32 v25, v158, v154, s58
    v_perm_b32 v26, v166, v162, s58
    v_perm_b32 v27, v174, v170, s58
    v_perm_b32 v28, v150, v146, s59
    v_perm_b32 v29, v158, v154, s59
    v_perm_b32 v30, v166, v162, s59
    v_perm_b32 v31, v174, v170, s59
    v_perm_b32 v32, v151, v147, s58
    v_perm_b32 v33, v159, v155, s58
    v_perm_b32 v34, v167, v163, s58
    v_perm_b32 v35, v175, v171, s58
    v_perm_b32 v36, v151, v147, s59
    v_perm_b32 v37, v159, v155, s59
    v_perm_b32 v38, v167, v163, s59
    v_perm_b32 v39, v175, v171, s59
    s_nop 1
    v_mfma_f32_16x16x32_bf16 v[64:67], v[24:27], v[40:43], v[64:67]
    v_mfma_f32_16x16x32_bf16 v[68:71], v[28:31], v[40:43], v[68:71]
    v_mfma_f32_16x16x32_bf16 v[72:75], v[32:35], v[40:43], v[72:75]
    v_mfma_f32_16x16x32_bf16 v[76:79], v[36:39], v[40:43], v[76:79]
    s_nop 7
    s_cmp_eq_u32 s9, 0
    s_cbranch_scc1 H_62_nov
    s_waitcnt vmcnt(12)
    s_add_u32 s46, s10, 0
    buffer_load_dwordx4 v[144:147], v2, s[32:35], s46 offen offset:0 nt
    buffer_load_dwordx4 v[148:151], v2, s[32:35], s46 offen offset:1024 nt
    buffer_load_dwordx4 v[152:155], v2, s[32:35], s46 offen offset:2048 nt
    buffer_load_dwordx4 v[156:159], v2, s[32:35], s46 offen offset:3072 nt
    s_waitcnt vmcnt(12)
    s_add_u32 s46, s10, 4096
    buffer_load_dwordx4 v[160:163], v2, s[32:35], s46 offen offset:0 nt
    buffer_load_dwordx4 v[164:167], v2, s[32:35], s46 offen offset:1024 nt
    buffer_load_dwordx4 v[168:171], v2, s[32:35], s46 offen offset:2048 nt
    buffer_load_dwordx4 v[172:175], v2, s[32:35], s46 offen offset:3072 nt
    s_branch H_62_cont
H_62_nov:
    s_cmp_eq_u32 s7, 0
    s_cbranch_scc1 H_62_cont
    s_waitcnt lgkmcnt(0)
    v_mov_b32 v6, 6756
    v_mov_b32 v7, 1
    s_mov_b64 exec, 1
    ds_add_u32 v6, v7
    s_mov_b64 exec, -1
H_62_cont:
    s_mov_b32 s12, s7
    s_mov_b32 s7, s9
    s_cmp_eq_u32 s12, 0
    s_cbranch_scc1 L_SEXIT
    s_branch L_SLOOP
L_SEXIT:
    s_nop 7
    v_mov_b32 v253, v249
    v_mov_b32 v251, v253
    s_nop 1
    v_permlane16_swap_b32 v253, v251
    s_nop 1
    v_add_f32 v253, v253, v251
    v_mov_b32 v251, v253
    s_nop 1
    v_permlane32_swap_b32 v253, v251
    s_nop 1
    v_add_f32 v253, v253, v251
    s_lshl_b32 s46, s44, 6
    v_lshlrev_b32 v3, 2, v0
    v_add_u32 v3, s46, v3
    s_mov_b64 exec, 0xff
    ds_write_b32 v3, v248 offset:6144
    ds_write_b32 v3, v253 offset:6176
    s_mov_b64 exec, -1
    s_waitcnt lgkmcnt(0)
    v_mov_b32 v6, 6724
    v_mov_b32 v7, 1
    s_mov_b64 exec, 1
    ds_add_u32 v6, v7
    s_mov_b64 exec, -1
    s_lshl_b32 s46, s44, 12
    v_lshlrev_b32 v3, 9, v4
    v_lshl_add_u32 v3, v5, 7, v3
    v_add_u32 v3, s46, v3
    s_mov_b32 exec_lo, 0x00ff00ff
    s_mov_b32 exec_hi, 0x00ff00ff
    ds_write_b128 v3, v[48:51] offset:8192
    ds_write_b128 v3, v[52:55] offset:8208
    ds_write_b128 v3, v[56:59] offset:8224
    ds_write_b128 v3, v[60:63] offset:8240
    ds_write_b128 v3, v[64:67] offset:8256
    ds_write_b128 v3, v[68:71] offset:8272
    ds_write_b128 v3, v[72:75] offset:8288
    ds_write_b128 v3, v[76:79] offset:8304
    s_mov_b64 exec, -1
    s_waitcnt lgkmcnt(0)
    v_mov_b32 v6, 6732
    v_mov_b32 v7, 1
    s_mov_b64 exec, 1
    ds_add_u32 v6, v7
    s_mov_b64 exec, -1
    s_lshr_b32 s46, s86, 6
    s_lshl_b32 s46, s46, 18
    s_lshl_b32 s49, s44, 16
    s_add_u32 s46, s46, s49
    s_bfe_u32 s49, s86, 0x10005
    s_lshl_b32 s49, s49, 14
    s_add_u32 s46, s46, s49
    s_and_b32 s49, s86, 31
    s_lshl_b32 s49, s49, 9
    s_add_u32 s46, s46, s49
    s_add_u32 s46, s46, 1572864
    v_and_b32 v2, 31, v0
    v_lshlrev_b32 v2, 4, v2
    v_lshrrev_b32 v1, 5, v0
    v_lshl_add_u32 v2, v1, 15, v2
    s_lshl_b32 s49, s44, 10
    v_lshlrev_b32 v3, 4, v0
    v_add_u32 v3, s49, v3
    s_lshl_b32 s49, s44, 3
    v_lshl_add_u32 v4, v1, 2, s49
    s_lshl_b32 s52, s86, 6
    s_add_u32 s52, s52, 2621440
    v_mov_b32 v6, 6732
    s_mov_b32 s51, 4000000
LW_63:
    ds_read_b32 v7, v6
    s_waitcnt lgkmcnt(0)
    v_readfirstlane_b32 s50, v7
    s_cmp_ge_u32 s50, 4
    s_cbranch_scc1 LWD_64
    s_sleep 1
    s_sub_u32 s51, s51, 1
    s_cmp_lg_u32 s51, 0
    s_cbranch_scc1 LW_63
LWD_64:
    ds_read_b32 v16, v4 offset:6144
    ds_read_b32 v20, v4 offset:6176
    ds_read_b32 v17, v4 offset:6208
    ds_read_b32 v21, v4 offset:6240
    ds_read_b32 v18, v4 offset:6272
    ds_read_b32 v22, v4 offset:6304
    ds_read_b32 v19, v4 offset:6336
    ds_read_b32 v23, v4 offset:6368
    ds_read_b128 v[88:91], v3 offset:8192
    ds_read_b128 v[92:95], v3 offset:12288
    ds_read_b128 v[96:99], v3 offset:16384
    ds_read_b128 v[100:103], v3 offset:20480
    s_waitcnt lgkmcnt(4)
    v_max3_f32 v24, v16, v17, v18
    v_max_f32 v24, v24, v19
    v_sub_f32 v16, v16, v24
    v_mul_f32 v16, s60, v16
    v_exp_f32 v16, v16
    v_sub_f32 v17, v17, v24
    v_mul_f32 v17, s60, v17
    v_exp_f32 v17, v17
    v_sub_f32 v18, v18, v24
    v_mul_f32 v18, s60, v18
    v_exp_f32 v18, v18
    v_sub_f32 v19, v19, v24
    v_mul_f32 v19, s60, v19
    v_exp_f32 v19, v19
    s_nop 0
    v_mul_f32 v25, v20, v16
    v_fma_f32 v25, v21, v17, v25
    v_fma_f32 v25, v22, v18, v25
    v_fma_f32 v25, v23, v19, v25
    s_waitcnt lgkmcnt(0)
    v_mul_f32 v8, v88, v16
    v_mul_f32 v12, v96, v18
    v_fma_f32 v8, v92, v17, v8
    v_fma_f32 v12, v100, v19, v12
    v_add_f32 v8, v8, v12
    v_mul_f32 v9, v89, v16
    v_mul_f32 v13, v97, v18
    v_fma_f32 v9, v93, v17, v9
    v_fma_f32 v13, v101, v19, v13
    v_add_f32 v9, v9, v13
    v_mul_f32 v10, v90, v16
    v_mul_f32 v14, v98, v18
    v_fma_f32 v10, v94, v17, v10
    v_fma_f32 v14, v102, v19, v14
    v_add_f32 v10, v10, v14
    v_mul_f32 v11, v91, v16
    v_mul_f32 v15, v99, v18
    v_fma_f32 v11, v95, v17, v11
    v_fma_f32 v15, v103, v19, v15
    v_add_f32 v11, v11, v15
    buffer_store_dwordx4 v[8:11], v2, s[36:39], s46 offen sc1
    s_mov_b32 exec_lo, 1
    s_mov_b32 exec_hi, 1
    buffer_store_dword v24, v4, s[36:39], s52 offen sc1
    buffer_store_dword v25, v4, s[36:39], s52 offen offset:32 sc1
    s_mov_b64 exec, -1
    v_mov_b32 v6, 6724
    v_mov_b32 v7, 1
    s_mov_b64 exec, 1
    ds_add_rtn_u32 v7, v6, v7
    s_waitcnt lgkmcnt(0)
    v_readfirstlane_b32 s49, v7
    s_mov_b64 exec, -1
    s_cmp_eq_u32 s49, 7
    s_cbranch_scc0 OA_65
    v_mov_b32 v6, 6744
    s_mov_b32 s51, 4000000
LW_66:
    ds_read_b32 v7, v6
    s_waitcnt lgkmcnt(0)
    v_readfirstlane_b32 s50, v7
    s_cmp_ge_u32 s50, 1
    s_cbranch_scc1 LWD_67
    s_sleep 1
    s_sub_u32 s51, s51, 1
    s_cmp_lg_u32 s51, 0
    s_cbranch_scc1 LW_66
LWD_67:
    s_mov_b32 s55, s50
    s_lshr_b32 s48, s86, 6
    s_add_u32 s48, s48, 8
    s_andn2_b32 s49, s86, 63
    s_add_u32 s49, s49, 257
    s_lshl_b32 s46, s49, 7
    s_add_u32 s46, s46, 3014656
    v_mov_b32 v6, s46
    v_mov_b32 v7, 1
    s_nop 0
    s_mov_b64 exec, 1
    buffer_atomic_add v7, v6, s[36:39], 0 offen sc0
    s_waitcnt vmcnt(0)
    v_readfirstlane_b32 s46, v7
    s_cmp_eq_u32 s46, 63
    s_cbranch_scc0 ARR_68
    s_lshl_b32 s46, s48, 7
    s_add_u32 s46, s46, 2883584
    v_mov_b32 v6, 0
    v_mov_b32 v7, s55
    buffer_store_dword v7, v6, s[36:39], s46 offen sc1
ARR_68:
    s_mov_b64 exec, -1
OA_65:
    s_endpgm
L_END:
    s_endpgm
.section .rodata,"a"
.p2align 6
.amdhsa_kernel recurrent_scan__gqa_block_cached__swiglu_ffn__decode_kernel
  .amdhsa_next_free_vgpr 256
  .amdhsa_next_free_sgpr 100
  .amdhsa_accum_offset 256
  .amdhsa_group_segment_fixed_size 0
  .amdhsa_kernarg_size 96
  .amdhsa_user_sgpr_count 2
  .amdhsa_user_sgpr_kernarg_segment_ptr 1
  .amdhsa_system_sgpr_workgroup_id_x 1
  .amdhsa_float_denorm_mode_32 3
.end_amdhsa_kernel
```
